```python
import torch

def _softmax(x, axis=-1):
    return torch.softmax(x, dim=axis)

def _gelu(x):
    return torch.nn.functional.gelu(x, approximate='tanh')

def _silu(x):
    return torch.nn.functional.silu(x)

def _sigmoid(x):
    return torch.sigmoid(x)

def _layernorm(x, axis=-1, eps=1e-05):
    m = x.mean(dim=axis, keepdim=True)
    v = x.var(dim=axis, keepdim=True, unbiased=False)
    return (x - m) / torch.sqrt(v + eps)

def _scatter_add(tgt, idx, src, axis=0):
    return tgt.clone().index_add_(axis, idx, src)

def _segment_sum(src, seg, n):
    out = torch.zeros((n,) + src.shape[1:], dtype=src.dtype)
    return out.index_add_(0, seg, src)

def _pad(x, pw):
    flat = tuple((v for pair in reversed(pw) for v in pair))
    return torch.nn.functional.pad(x, flat)
kernel_name = 'parallel_sum__linear_attn_block__mixer_gmlp__prompt'

def setup_inputs():

    _w = lambda a: (lambda t: t.to(torch.bfloat16) if t.is_floating_point() else t)(torch.as_tensor(a))

    def _A_setup():
        B, S, D = (1, 2048, 640)
        return {'x': _w((lambda *s: torch.randn(*s, dtype=torch.bfloat16) * 0.05)(B, S, D)), 'wqkv': _w((lambda *s: torch.randn(*s, dtype=torch.bfloat16) * 0.8)(D, 3 * D)), 'wo': _w((lambda *s: torch.randn(*s, dtype=torch.bfloat16) * 0.2)(D, D))}
    _A_in = _A_setup()

    def _B_setup():
        B, S, D, F = (1, 2048, 640, 1728)
        Fh = F // 2
        return {'x': _w((lambda *s: torch.randn(*s, dtype=torch.bfloat16) * 0.05)(B, S, D)), 'w_in': _w((lambda *s: torch.randn(*s, dtype=torch.bfloat16) * 0.4)(D, 2 * Fh)), 'w_sp': _w(0.01 * (lambda *s: torch.randn(*s, dtype=torch.bfloat16) * 0.4)(S, S)), 'b_sp': _w(1.0 + 0.01 * (lambda *s: torch.randn(*s, dtype=torch.bfloat16) * 0.05)(S)), 'w_out': _w((lambda *s: torch.randn(*s, dtype=torch.bfloat16) * 0.05)(Fh, D))}
    _B_in = _B_setup()
    return {'A_x': _A_in['x'], 'A_wqkv': _A_in['wqkv'], 'A_wo': _A_in['wo'], 'B_x': _B_in['x'], 'B_w_in': _B_in['w_in'], 'B_w_sp': _B_in['w_sp'], 'B_b_sp': _B_in['b_sp'], 'B_w_out': _B_in['w_out']}

def reference(A_x, A_wqkv, A_wo, B_x, B_w_in, B_w_sp, B_b_sp, B_w_out):

    def _A_ref(x, wqkv, wo):
        B, S, D = x.shape
        H = 32
        Dh = D // H
        qkv = (lambda x, *d: x.permute(*d))((x @ wqkv).reshape(B, S, 3, H, Dh), 2, 0, 3, 1, 4)
        q, k, v = (qkv[0], qkv[1], qkv[2])
        phi = lambda t: torch.where(t > 0, t + 1, torch.exp(t)) + 1e-06
        pq, pk = (phi(q), phi(k))
        kv = torch.einsum('bhsd,bhse->bhde', pk, v)
        z = torch.einsum('bhsd->bhd', pk)
        num = torch.einsum('bhqd,bhde->bhqe', pq, kv)
        den = torch.einsum('bhqd,bhd->bhq', pq, z)[..., None] + 1e-06
        o = num / den
        return (lambda x, *d: x.permute(*d))(o, 0, 2, 1, 3).reshape(B, S, D) @ wo

    def _B_ref(x, w_in, w_sp, b_sp, w_out):
        B, S, D = x.shape
        F = w_in.shape[-1]
        Fh = F // 2
        z = _gelu(torch.einsum('bsd,df->bsf', x, w_in))
        z1 = z[..., :Fh].clone()
        z2 = _layernorm(z[..., Fh:], axis=-1)
        g = torch.einsum('ts,bsf->btf', w_sp, z2) + b_sp[None, :, None]
        return torch.einsum('bsf,fd->bsd', z1 * g, w_out)
    x = A_x
    xn = _layernorm(x, axis=-1)
    return x + _A_ref(xn, A_wqkv, A_wo) + _B_ref(xn, B_w_in, B_w_sp, B_b_sp, B_w_out)
```

```asm
; @launch kernel=k1_kernel grid=(256,1,1) block=(512,1,1) lds=163840
.amdgcn_target "amdgcn-amd-amdhsa--gfx950"
.text
.globl k1_kernel
.type k1_kernel,@function
.p2align 8
k1_kernel:
  s_cmp_ge_u32 s2, 256
  s_cbranch_scc1 K1_end
  s_load_dwordx4 s[48:51], s[0:1], 0
  s_load_dwordx2 s[54:55], s[0:1], 32
  s_load_dwordx2 s[58:59], s[0:1], 40
  s_load_dwordx4 s[60:63], s[0:1], 72
  v_lshrrev_b32 v1, 6, v0
  v_and_b32 v0, 63, v0
  v_readfirstlane_b32 s26, v1
  s_bfe_u32 s24, s2, 0x10002
  s_lshl_b32 s24, s24, 3
  s_lshr_b32 s36, s2, 5
  s_add_u32 s24, s24, s36
  s_and_b32 s67, s2, 1
  s_lshl_b32 s67, s67, 1
  s_bfe_u32 s36, s2, 0x10001
  s_add_u32 s67, s67, s36
  s_bfe_u32 s36, s2, 0x20003
  s_mul_i32 s25, s67, 3
  s_add_u32 s25, s25, s36
  s_add_u32 s67, s67, 12
  s_cmp_eq_u32 s36, 3
  s_cselect_b32 s25, s67, s25
  s_and_b32 s27, s26, 3
  s_lshr_b32 s28, s26, 2
  s_cmp_eq_u32 s25, 15
  s_cbranch_scc1 K1_side
  v_lshrrev_b32 v3, 3, v0
  s_lshl_b32 s36, s26, 4
  v_add_u32 v3, s36, v3
  v_lshrrev_b32 v1, 4, v0
  v_and_b32 v2, 7, v0
  v_xor_b32 v4, v1, v2
  v_mul_u32_u24 v5, 1280, v3
  v_lshl_add_u32 v44, v4, 4, v5
  v_xor_b32 v4, 4, v4
  v_lshl_add_u32 v45, v4, 4, v5
  v_add_u32 v45, 9216, v45
  v_and_b32 v1, 1, v1
  v_lshlrev_b32 v1, 2, v1
  v_xor_b32 v2, v1, v2
  v_lshlrev_b32 v2, 4, v2
  v_mul_u32_u24 v46, 3456, v3
  v_add_u32 v46, v46, v2
  v_add_u32 v47, 26624, v46
  s_mul_i32 s29, s24, 163840
  s_add_u32 s71, s25, 13
  s_cmp_eq_u32 s25, 14
  s_cselect_b32 s71, 12, s71
  s_cselect_b32 s47, 1, 0
  s_lshl_b32 s30, s71, 7
  s_mul_i32 s35, s27, 20480
  s_lshl_b32 s36, s28, 11
  s_add_u32 s35, s35, s36
  s_add_u32 s35, s35, 81920
  s_lshr_b32 s36, s26, 1
  s_mul_i32 s37, s36, 20480
  s_and_b32 s36, s26, 1
  s_lshl_b32 s36, s36, 11
  s_add_u32 s37, s37, s36
  s_add_u32 s37, s37, 81920
  s_waitcnt lgkmcnt(0)
  s_mov_b32 s4, s48
  s_and_b32 s5, s49, 0xffff
  s_mov_b32 s6, 0x280000
  s_mov_b32 s7, 0x20000
  s_mov_b32 s8, s54
  s_and_b32 s9, s55, 0xffff
  s_mov_b32 s10, 0x21c000
  s_mov_b32 s11, 0x20000
  s_add_u32 m0, s37, 0
  s_nop 0
  buffer_load_dwordx4 v44, s[4:7], s29 offen lds
  buffer_load_dwordx4 v45, s[4:7], s29 offen offset:1024 lds
  s_add_u32 s29, s29, 128
  s_add_u32 m0, s35, -81920
  s_nop 0
  buffer_load_dwordx4 v46, s[8:11], s30 offen lds
  buffer_load_dwordx4 v47, s[8:11], s30 offen offset:1024 lds
  s_add_u32 s30, s30, 442368
  s_cmp_eq_u32 s26, 7
  s_cbranch_scc1 K1_pfcode
  s_cmp_gt_u32 s26, 3
  s_cbranch_scc1 Lpf_1
  s_cmp_ge_u32 s26, 2
  s_cbranch_scc1 K1_pfw0
  s_mul_i32 s36, s25, 11008
  s_mul_i32 s67, s26, 5504
  s_add_u32 s36, s36, s67
  s_mul_i32 s67, s24, 163840
  s_add_u32 s36, s36, s67
  v_min_u32 v76, 42, v0
  v_lshlrev_b32 v76, 7, v76
  buffer_load_dword v77, v76, s[4:7], s36 offen
  s_branch Lpf_1
K1_pfw0:
  s_mul_i32 s36, s24, 15
  s_add_u32 s36, s36, s25
  s_lshl_b32 s36, s36, 1
  s_add_u32 s36, s36, s26
  s_sub_u32 s36, s36, 2
  s_mul_i32 s36, s36, 4608
  v_min_u32 v76, 35, v0
  v_lshlrev_b32 v76, 7, v76
  buffer_load_dword v77, v76, s[8:11], s36 offen
  s_branch Lpf_1
K1_pfcode:
  s_getpc_b64 s[52:53]
K1_pc:
  s_sub_u32 s52, s52, K1_pc-k1_kernel
  s_subb_u32 s53, s53, 0
  s_bfe_u32 s36, s2, 0x30003
  s_lshl_b32 s36, s36, 6
  v_add_u32 v76, s36, v0
  v_lshlrev_b32 v76, 7, v76
  v_min_u32 v76, (CODE_END-k1_kernel-4), v76
  global_load_dword v77, v76, s[52:53]
Lpf_1:
  s_add_u32 m0, s37, 4096
  s_nop 0
  buffer_load_dwordx4 v44, s[4:7], s29 offen lds
  buffer_load_dwordx4 v45, s[4:7], s29 offen offset:1024 lds
  s_add_u32 s29, s29, 128
  v_mov_b32 v72, v3
  v_mov_b32 v73, v2
  s_xor_b32 s67, s27, s28
  v_lshrrev_b32 v1, 5, v0
  v_and_b32 v65, 31, v0
  v_lshlrev_b32 v65, 7, v65
  v_bfe_u32 v66, v0, 1, 3
  v_xor_b32 v66, v66, v1
  s_lshl_b32 s36, s67, 1
  v_xor_b32 v66, s36, v66
  v_lshl_add_u32 v65, v66, 4, v65
  s_mul_i32 s36, s27, 20480
  s_add_u32 s36, s36, 81920
  v_add_u32 v40, s36, v65
  v_xor_b32 v41, 32, v40
  v_xor_b32 v42, 64, v40
  v_xor_b32 v43, 96, v40
  v_bfe_u32 v64, v0, 2, 2
  v_lshl_add_u32 v64, v1, 3, v64
  v_lshlrev_b32 v64, 7, v64
  v_bfe_u32 v65, v0, 4, 1
  v_lshlrev_b32 v65, 1, v65
  v_bfe_u32 v66, v0, 1, 1
  v_add_u32 v65, v65, v66
  s_lshl_b32 s36, s28, 2
  v_add_u32 v65, s36, v65
  v_bfe_u32 v66, v0, 3, 1
  v_lshlrev_b32 v66, 2, v66
  v_xor_b32 v65, v65, v66
  v_lshl_add_u32 v64, v65, 4, v64
  v_and_b32 v65, 1, v0
  v_lshl_add_u32 v64, v65, 3, v64
  s_xor_b32 s36, s67, 0
  s_mul_i32 s36, s36, 20480
  v_add_u32 v8, s36, v64
  s_xor_b32 s36, s67, 1
  s_mul_i32 s36, s36, 20480
  v_add_u32 v9, s36, v64
  s_xor_b32 s36, s67, 2
  s_mul_i32 s36, s36, 20480
  v_add_u32 v10, s36, v64
  s_xor_b32 s36, s67, 3
  s_mul_i32 s36, s36, 20480
  v_add_u32 v11, s36, v64
  s_add_u32 m0, s37, 8192
  s_nop 0
  buffer_load_dwordx4 v44, s[4:7], s29 offen lds
  buffer_load_dwordx4 v45, s[4:7], s29 offen offset:1024 lds
  s_add_u32 s29, s29, 128
  s_add_u32 m0, s35, -77824
  s_nop 0
  buffer_load_dwordx4 v46, s[8:11], s30 offen lds
  buffer_load_dwordx4 v47, s[8:11], s30 offen offset:1024 lds
  s_add_u32 s30, s30, 442368
  s_mov_b32 s39, 0x3f803f80
  v_lshrrev_b32 v65, 4, v0
  v_bfe_u32 v66, v0, 2, 2
  v_cmp_eq_u32 vcc, v65, v66
  v_mov_b32 v65, s39
  s_nop 0
  v_cndmask_b32 v24, 0, v65, vcc
  v_cndmask_b32 v25, 0, v65, vcc
  v_cndmask_b32 v26, 0, v65, vcc
  v_cndmask_b32 v27, 0, v65, vcc
  s_waitcnt vmcnt(6)
  s_barrier
  ds_read_b128 v[96:99], v40 offset:0
  ds_read_b128 v[100:103], v41 offset:0
  ds_read_b128 v[104:107], v42 offset:0
  ds_read_b128 v[108:111], v43 offset:0
  ds_read_b64_tr_b16 v[48:49], v8 offset:0
  ds_read_b64_tr_b16 v[50:51], v8 offset:512
  ds_read_b64_tr_b16 v[52:53], v9 offset:0
  ds_read_b64_tr_b16 v[54:55], v9 offset:512
  ds_read_b64_tr_b16 v[56:57], v10 offset:0
  ds_read_b64_tr_b16 v[58:59], v10 offset:512
  s_add_u32 m0, s37, 12288
  s_nop 0
  buffer_load_dwordx4 v44, s[4:7], s29 offen lds
  buffer_load_dwordx4 v45, s[4:7], s29 offen offset:1024 lds
  s_add_u32 s29, s29, 128
  s_add_u32 m0, s37, 16384
  s_nop 0
  buffer_load_dwordx4 v44, s[4:7], s29 offen lds
  buffer_load_dwordx4 v45, s[4:7], s29 offen offset:1024 lds
  s_add_u32 s29, s29, 128
  s_waitcnt lgkmcnt(6)
  s_waitcnt vmcnt(8)
  s_barrier
  s_waitcnt lgkmcnt(4)
  v_mfma_f32_32x32x16_bf16 v[80:95], v[48:51], v[96:99], 0
  ds_read_b64_tr_b16 v[60:61], v11 offset:0
  ds_read_b64_tr_b16 v[62:63], v11 offset:512
  ds_read_b128 v[112:115], v40 offset:4096
  ds_read_b128 v[116:119], v41 offset:4096
  s_add_u32 m0, s35, -73728
  s_nop 0
  buffer_load_dwordx4 v46, s[8:11], s30 offen lds
  s_mov_b32 s12, s50
  s_and_b32 s13, s51, 0xffff
  s_mov_b32 s14, 0x258000
  s_mov_b32 s15, 0x20000
  v_mul_u32_u24 v7, 3840, v72
  v_mfma_f32_16x16x32_bf16 v[20:23], v[24:27], v[48:51], 0
  v_mfma_f32_4x4x4_16b_bf16 v[28:31], v[96:97], v[96:97], 0
  v_mfma_f32_4x4x4_16b_bf16 v[32:35], v[98:99], v[98:99], 0
  v_mfma_f32_16x16x32_bf16 v[36:39], v[24:27], v[96:99], 0
  s_waitcnt lgkmcnt(6)
  v_mfma_f32_32x32x16_bf16 v[80:95], v[52:55], v[100:103], v[80:95]
  ds_read_b64_tr_b16 v[48:49], v8 offset:2048
  ds_read_b64_tr_b16 v[50:51], v8 offset:2560
  ds_read_b128 v[120:123], v42 offset:4096
  ds_read_b128 v[124:127], v43 offset:4096
  buffer_load_dwordx4 v47, s[8:11], s30 offen offset:1024 lds
  s_add_u32 s30, s30, 442368
  v_add_u32 v7, v7, v73
  v_add_u32 v6, 29696, v7
  s_lshl_b32 s36, s71, 1
  s_add_u32 s36, s36, s28
  s_cmp_ge_u32 s36, 27
  s_cselect_b32 s45, 1.0, 0
  s_waitcnt lgkmcnt(8)
  v_mfma_f32_32x32x16_bf16 v[80:95], v[56:59], v[104:107], v[80:95]
  ds_read_b64_tr_b16 v[52:53], v9 offset:2048
  ds_read_b64_tr_b16 v[54:55], v9 offset:2560
  s_add_u32 m0, s37, 0
  s_nop 0
  buffer_load_dwordx4 v44, s[4:7], s29 offen lds
  s_lshl_b32 s68, s24, 2
  s_add_u32 s68, s68, s27
  s_mul_i32 s40, s68, 110592
  s_add_u32 s40, s40, 0x780000
  s_lshl_b32 s43, s36, 11
  v_mfma_f32_4x4x4_16b_bf16 v[28:31], v[104:105], v[104:105], v[28:31]
  v_mfma_f32_4x4x4_16b_bf16 v[32:35], v[106:107], v[106:107], v[32:35]
  v_mfma_f32_16x16x32_bf16 v[36:39], v[24:27], v[104:107], v[36:39]
  s_waitcnt lgkmcnt(8)
  v_mfma_f32_32x32x16_bf16 v[80:95], v[60:63], v[108:111], v[80:95]
  ds_read_b64_tr_b16 v[56:57], v10 offset:2048
  ds_read_b64_tr_b16 v[58:59], v10 offset:2560
  buffer_load_dwordx4 v45, s[4:7], s29 offen offset:1024 lds
  s_add_u32 s29, s29, 128
  s_add_u32 s43, s43, s40
  s_cmp_lg_u32 s45, 0
  s_cselect_b32 s69, s43, 0x40000000
  s_cselect_b32 s43, 0x40000000, s43
  s_sub_u32 s70, s35, 73728
  s_lshl_b32 s66, s68, 12
  s_lshl_b32 s36, s25, 8
  s_waitcnt lgkmcnt(4)
  s_waitcnt vmcnt(8)
  s_barrier
  v_mfma_f32_32x32x16_bf16 v[80:95], v[48:51], v[112:115], v[80:95]
  ds_read_b64_tr_b16 v[60:61], v11 offset:2048
  ds_read_b64_tr_b16 v[62:63], v11 offset:2560
  ds_read_b128 v[128:131], v40 offset:8192
  ds_read_b128 v[132:135], v41 offset:8192
  s_add_u32 m0, s37, 4096
  s_nop 0
  buffer_load_dwordx4 v44, s[4:7], s29 offen lds
  s_add_u32 s66, s66, s36
  s_add_u32 s66, s66, 0x16b0000
  s_lshl_b32 s36, s25, 1
  s_mul_i32 s67, s25, 3
  s_sub_u32 s67, s67, 11
  v_mfma_f32_16x16x32_bf16 v[20:23], v[24:27], v[48:51], v[20:23]
  v_mfma_f32_4x4x4_16b_bf16 v[28:31], v[112:113], v[112:113], v[28:31]
  v_mfma_f32_4x4x4_16b_bf16 v[32:35], v[114:115], v[114:115], v[32:35]
  v_mfma_f32_16x16x32_bf16 v[36:39], v[24:27], v[112:115], v[36:39]
  s_waitcnt lgkmcnt(6)
  v_mfma_f32_32x32x16_bf16 v[80:95], v[52:55], v[116:119], v[80:95]
  ds_read_b64_tr_b16 v[48:49], v8 offset:4096
  ds_read_b64_tr_b16 v[50:51], v8 offset:4608
  ds_read_b128 v[136:139], v42 offset:8192
  ds_read_b128 v[140:143], v43 offset:8192
  s_cmp_lt_u32 s25, 12
  s_cselect_b32 s71, s36, s67
  s_cselect_b32 s46, 1, 0
  s_lshl_b32 s31, s71, 7
  s_mul_i32 s3, s68, 122880
  s_lshl_b32 s36, s71, 12
  s_add_u32 s3, s3, s36
  s_waitcnt lgkmcnt(8)
  v_mfma_f32_32x32x16_bf16 v[80:95], v[56:59], v[120:123], v[80:95]
  ds_read_b64_tr_b16 v[52:53], v9 offset:4096
  ds_read_b64_tr_b16 v[54:55], v9 offset:4608
  buffer_load_dwordx4 v45, s[4:7], s29 offen offset:1024 lds
  s_add_u32 s29, s29, 128
  s_lshl_b32 s67, s28, 11
  s_add_u32 s3, s3, s67
  s_sub_u32 s71, s71, 1
  s_lshl_b32 s36, s25, 12
  v_mfma_f32_4x4x4_16b_bf16 v[28:31], v[120:121], v[120:121], v[28:31]
  v_mfma_f32_4x4x4_16b_bf16 v[32:35], v[122:123], v[122:123], v[32:35]
  v_mfma_f32_16x16x32_bf16 v[36:39], v[24:27], v[120:123], v[36:39]
  s_waitcnt lgkmcnt(8)
  v_mfma_f32_32x32x16_bf16 v[80:95], v[60:63], v[124:127], v[80:95]
  ds_read_b64_tr_b16 v[56:57], v10 offset:4096
  ds_read_b64_tr_b16 v[58:59], v10 offset:4608
  s_add_u32 s36, s36, s67
  s_add_u32 s36, s36, s40
  s_sub_u32 s67, s3, 4096
  s_cmp_lt_u32 s25, 12
  s_cselect_b32 s64, s36, s67
  s_cselect_b32 s33, s25, s71
  s_mov_b32 s32, 491520
  s_cselect_b32 s32, 442368, s32
  s_cselect_b64 s[52:53], s[8:9], s[12:13]
  s_cselect_b32 s54, s10, s14
  s_cselect_b64 vcc, -1, 0
  s_waitcnt lgkmcnt(4)
  s_waitcnt vmcnt(8)
  s_barrier
  v_mfma_f32_32x32x16_bf16 v[80:95], v[48:51], v[128:131], v[80:95]
  ds_read_b64_tr_b16 v[60:61], v11 offset:4096
  ds_read_b64_tr_b16 v[62:63], v11 offset:4608
  ds_read_b128 v[144:147], v40 offset:12288
  ds_read_b128 v[148:151], v41 offset:12288
  s_add_u32 m0, s35, -69632
  s_nop 0
  buffer_load_dwordx4 v46, s[8:11], s30 offen lds
  s_mov_b32 s55, 0x20000
  v_cndmask_b32 v74, v7, v46, vcc
  v_cndmask_b32 v75, v6, v47, vcc
  s_lshl_b32 s33, s33, 7
  v_mfma_f32_16x16x32_bf16 v[20:23], v[24:27], v[48:51], v[20:23]
  v_mfma_f32_4x4x4_16b_bf16 v[28:31], v[128:129], v[128:129], v[28:31]
  v_mfma_f32_4x4x4_16b_bf16 v[32:35], v[130:131], v[130:131], v[32:35]
  v_mfma_f32_16x16x32_bf16 v[36:39], v[24:27], v[128:131], v[36:39]
  s_waitcnt lgkmcnt(6)
  v_mfma_f32_32x32x16_bf16 v[80:95], v[52:55], v[132:135], v[80:95]
  ds_read_b64_tr_b16 v[48:49], v8 offset:6144
  ds_read_b64_tr_b16 v[50:51], v8 offset:6656
  ds_read_b128 v[152:155], v42 offset:12288
  ds_read_b128 v[156:159], v43 offset:12288
  buffer_load_dwordx4 v47, s[8:11], s30 offen offset:1024 lds
  s_add_u32 s30, s30, 442368
  s_cmp_eq_u32 s47, 1
  s_cselect_b32 s33, 0x40000000, s33
  s_cselect_b32 s31, 0x40000000, s31
  s_mov_b32 s16, s62
  s_and_b32 s17, s63, 0xffff
  s_mov_b32 s18, 0x1730000
  s_waitcnt lgkmcnt(8)
  v_mfma_f32_32x32x16_bf16 v[80:95], v[56:59], v[136:139], v[80:95]
  ds_read_b64_tr_b16 v[52:53], v9 offset:6144
  ds_read_b64_tr_b16 v[54:55], v9 offset:6656
  s_add_u32 m0, s37, 8192
  s_nop 0
  buffer_load_dwordx4 v44, s[4:7], s29 offen lds
  s_mov_b32 s19, 0x20000
  s_mov_b32 s20, s60
  s_and_b32 s21, s61, 0xffff
  s_mov_b32 s22, 0x100
  v_mfma_f32_4x4x4_16b_bf16 v[28:31], v[136:137], v[136:137], v[28:31]
  v_mfma_f32_4x4x4_16b_bf16 v[32:35], v[138:139], v[138:139], v[32:35]
  v_mfma_f32_16x16x32_bf16 v[36:39], v[24:27], v[136:139], v[36:39]
  s_waitcnt lgkmcnt(8)
  v_mfma_f32_32x32x16_bf16 v[80:95], v[60:63], v[140:143], v[80:95]
  ds_read_b64_tr_b16 v[56:57], v10 offset:6144
  ds_read_b64_tr_b16 v[58:59], v10 offset:6656
  buffer_load_dwordx4 v45, s[4:7], s29 offen offset:1024 lds
  s_add_u32 s29, s29, 128
  s_mov_b32 s23, 0x20000
  v_lshlrev_b32 v65, 2, v1
  v_xor_b32 v65, v65, v0
  v_lshlrev_b32 v5, 4, v65
  s_waitcnt lgkmcnt(4)
  s_waitcnt vmcnt(8)
  s_barrier
  v_mfma_f32_32x32x16_bf16 v[80:95], v[48:51], v[144:147], v[80:95]
  ds_read_b64_tr_b16 v[60:61], v11 offset:6144
  ds_read_b64_tr_b16 v[62:63], v11 offset:6656
  ds_read_b128 v[160:163], v40 offset:16384
  ds_read_b128 v[164:167], v41 offset:16384
  s_add_u32 m0, s37, 12288
  s_nop 0
  buffer_load_dwordx4 v44, s[4:7], s29 offen lds
  v_xor_b32 v4, 0x80, v5
  v_add_u32 v4, 1024, v4
  s_lshl_b32 s36, s28, 10
  s_add_u32 s36, s36, 12288
  v_mfma_f32_16x16x32_bf16 v[20:23], v[24:27], v[48:51], v[20:23]
  v_mfma_f32_4x4x4_16b_bf16 v[28:31], v[144:145], v[144:145], v[28:31]
  v_mfma_f32_4x4x4_16b_bf16 v[32:35], v[146:147], v[146:147], v[32:35]
  v_mfma_f32_16x16x32_bf16 v[36:39], v[24:27], v[144:147], v[36:39]
  s_waitcnt lgkmcnt(6)
  v_mfma_f32_32x32x16_bf16 v[80:95], v[52:55], v[148:151], v[80:95]
  ds_read_b64_tr_b16 v[48:49], v8 offset:8192
  ds_read_b64_tr_b16 v[50:51], v8 offset:8704
  ds_read_b128 v[168:171], v42 offset:16384
  ds_read_b128 v[172:175], v43 offset:16384
  v_lshlrev_b32 v3, 4, v0
  v_add_u32 v3, s36, v3
  s_lshl_b32 s36, s27, 2
  v_add_u32 v2, s36, v3
  s_waitcnt lgkmcnt(8)
  v_mfma_f32_32x32x16_bf16 v[80:95], v[56:59], v[152:155], v[80:95]
  ds_read_b64_tr_b16 v[52:53], v9 offset:8192
  ds_read_b64_tr_b16 v[54:55], v9 offset:8704
  buffer_load_dwordx4 v45, s[4:7], s29 offen offset:1024 lds
  s_add_u32 s29, s29, 128
  v_mov_b32 v12, 0
  v_mov_b32 v13, 0
  s_mov_b32 s34, 81920
  s_mov_b32 s38, s47
  v_mfma_f32_4x4x4_16b_bf16 v[28:31], v[152:153], v[152:153], v[28:31]
  v_mfma_f32_4x4x4_16b_bf16 v[32:35], v[154:155], v[154:155], v[32:35]
  v_mfma_f32_16x16x32_bf16 v[36:39], v[24:27], v[152:155], v[36:39]
  s_waitcnt lgkmcnt(8)
  v_mfma_f32_32x32x16_bf16 v[80:95], v[60:63], v[156:159], v[80:95]
  ds_read_b64_tr_b16 v[56:57], v10 offset:8192
  ds_read_b64_tr_b16 v[58:59], v10 offset:8704
  s_lshl_b32 s68, s24, 11
  s_add_u32 s68, s68, 0x16a0000
  s_cmp_eq_u32 s26, 0
  s_cselect_b32 s65, 2, 99
  s_cmp_eq_u32 s28, 0
  s_cselect_b32 s57, s66, 0x40000000
  s_waitcnt lgkmcnt(4)
  s_waitcnt vmcnt(8)
  s_barrier
  v_mfma_f32_32x32x16_bf16 v[80:95], v[48:51], v[160:163], v[80:95]
  ds_read_b64_tr_b16 v[60:61], v11 offset:8192
  ds_read_b64_tr_b16 v[62:63], v11 offset:8704
  ds_read_b128 v[176:179], v40 offset:0
  ds_read_b128 v[180:183], v41 offset:0
  s_add_u32 m0, s35, -65536
  s_nop 0
  buffer_load_dwordx4 v46, s[8:11], s30 offen lds
  v_mfma_f32_16x16x32_bf16 v[20:23], v[24:27], v[48:51], v[20:23]
  v_mfma_f32_4x4x4_16b_bf16 v[28:31], v[160:161], v[160:161], v[28:31]
  v_mfma_f32_4x4x4_16b_bf16 v[32:35], v[162:163], v[162:163], v[32:35]
  v_mfma_f32_16x16x32_bf16 v[36:39], v[24:27], v[160:163], v[36:39]
  s_waitcnt lgkmcnt(6)
  v_mfma_f32_32x32x16_bf16 v[80:95], v[52:55], v[164:167], v[80:95]
  ds_read_b64_tr_b16 v[48:49], v8 offset:10240
  ds_read_b64_tr_b16 v[50:51], v8 offset:10752
  ds_read_b128 v[184:187], v42 offset:0
  ds_read_b128 v[188:191], v43 offset:0
  buffer_load_dwordx4 v47, s[8:11], s30 offen offset:1024 lds
  s_add_u32 s30, s30, 442368
  s_waitcnt lgkmcnt(8)
  v_mfma_f32_32x32x16_bf16 v[80:95], v[56:59], v[168:171], v[80:95]
  ds_read_b64_tr_b16 v[52:53], v9 offset:10240
  ds_read_b64_tr_b16 v[54:55], v9 offset:10752
  s_add_u32 m0, s37, 16384
  s_nop 0
  buffer_load_dwordx4 v44, s[4:7], s29 offen lds
  v_mfma_f32_4x4x4_16b_bf16 v[28:31], v[168:169], v[168:169], v[28:31]
  v_mfma_f32_4x4x4_16b_bf16 v[32:35], v[170:171], v[170:171], v[32:35]
  v_mfma_f32_16x16x32_bf16 v[36:39], v[24:27], v[168:171], v[36:39]
  s_waitcnt lgkmcnt(8)
  v_mfma_f32_32x32x16_bf16 v[80:95], v[60:63], v[172:175], v[80:95]
  ds_read_b64_tr_b16 v[56:57], v10 offset:10240
  ds_read_b64_tr_b16 v[58:59], v10 offset:10752
  buffer_load_dwordx4 v45, s[4:7], s29 offen offset:1024 lds
  s_add_u32 s29, s29, 128
  s_waitcnt lgkmcnt(4)
  s_waitcnt vmcnt(8)
  s_barrier
  v_mfma_f32_32x32x16_bf16 v[80:95], v[48:51], v[176:179], v[80:95]
  ds_read_b64_tr_b16 v[60:61], v11 offset:10240
  ds_read_b64_tr_b16 v[62:63], v11 offset:10752
  ds_read_b128 v[192:195], v40 offset:4096
  ds_read_b128 v[196:199], v41 offset:4096
  s_add_u32 m0, s35, 0
  s_nop 0
  buffer_load_dwordx4 v74, s[52:55], s33 offen lds
  v_mfma_f32_16x16x32_bf16 v[20:23], v[24:27], v[48:51], v[20:23]
  v_mfma_f32_4x4x4_16b_bf16 v[28:31], v[176:177], v[176:177], v[28:31]
  v_mfma_f32_4x4x4_16b_bf16 v[32:35], v[178:179], v[178:179], v[32:35]
  v_mfma_f32_16x16x32_bf16 v[36:39], v[24:27], v[176:179], v[36:39]
  s_waitcnt lgkmcnt(6)
  v_mfma_f32_32x32x16_bf16 v[80:95], v[52:55], v[180:183], v[80:95]
  ds_read_b64_tr_b16 v[48:49], v8 offset:12288
  ds_read_b64_tr_b16 v[50:51], v8 offset:12800
  ds_read_b128 v[200:203], v42 offset:4096
  ds_read_b128 v[204:207], v43 offset:4096
  s_waitcnt lgkmcnt(8)
  v_mfma_f32_32x32x16_bf16 v[80:95], v[56:59], v[184:187], v[80:95]
  ds_read_b64_tr_b16 v[52:53], v9 offset:12288
  ds_read_b64_tr_b16 v[54:55], v9 offset:12800
  buffer_load_dwordx4 v75, s[52:55], s33 offen offset:1024 lds
  s_add_u32 s33, s33, s32
  v_mfma_f32_4x4x4_16b_bf16 v[28:31], v[184:185], v[184:185], v[28:31]
  v_mfma_f32_4x4x4_16b_bf16 v[32:35], v[186:187], v[186:187], v[32:35]
  v_mfma_f32_16x16x32_bf16 v[36:39], v[24:27], v[184:187], v[36:39]
  s_waitcnt lgkmcnt(8)
  v_mfma_f32_32x32x16_bf16 v[80:95], v[60:63], v[188:191], v[80:95]
  ds_read_b64_tr_b16 v[56:57], v10 offset:12288
  ds_read_b64_tr_b16 v[58:59], v10 offset:12800
  s_waitcnt lgkmcnt(4)
  s_waitcnt vmcnt(8)
  s_barrier
  v_mfma_f32_32x32x16_bf16 v[80:95], v[48:51], v[192:195], v[80:95]
  ds_read_b64_tr_b16 v[60:61], v11 offset:12288
  ds_read_b64_tr_b16 v[62:63], v11 offset:12800
  ds_read_b128 v[208:211], v40 offset:8192
  ds_read_b128 v[212:215], v41 offset:8192
  s_add_u32 m0, s35, 4096
  s_nop 0
  buffer_load_dwordx4 v74, s[52:55], s33 offen lds
  v_mfma_f32_16x16x32_bf16 v[20:23], v[24:27], v[48:51], v[20:23]
  v_mfma_f32_4x4x4_16b_bf16 v[28:31], v[192:193], v[192:193], v[28:31]
  v_mfma_f32_4x4x4_16b_bf16 v[32:35], v[194:195], v[194:195], v[32:35]
  v_mfma_f32_16x16x32_bf16 v[36:39], v[24:27], v[192:195], v[36:39]
  s_waitcnt lgkmcnt(6)
  v_mfma_f32_32x32x16_bf16 v[80:95], v[52:55], v[196:199], v[80:95]
  ds_read_b64_tr_b16 v[48:49], v8 offset:14336
  ds_read_b64_tr_b16 v[50:51], v8 offset:14848
  ds_read_b128 v[216:219], v42 offset:8192
  ds_read_b128 v[220:223], v43 offset:8192
  s_waitcnt lgkmcnt(8)
  v_mfma_f32_32x32x16_bf16 v[80:95], v[56:59], v[200:203], v[80:95]
  ds_read_b64_tr_b16 v[52:53], v9 offset:14336
  ds_read_b64_tr_b16 v[54:55], v9 offset:14848
  buffer_load_dwordx4 v75, s[52:55], s33 offen offset:1024 lds
  s_add_u32 s33, s33, s32
  v_mfma_f32_4x4x4_16b_bf16 v[28:31], v[200:201], v[200:201], v[28:31]
  v_mfma_f32_4x4x4_16b_bf16 v[32:35], v[202:203], v[202:203], v[32:35]
  v_mfma_f32_16x16x32_bf16 v[36:39], v[24:27], v[200:203], v[36:39]
  s_waitcnt lgkmcnt(8)
  v_mfma_f32_32x32x16_bf16 v[80:95], v[60:63], v[204:207], v[80:95]
  ds_read_b64_tr_b16 v[56:57], v10 offset:14336
  ds_read_b64_tr_b16 v[58:59], v10 offset:14848
  s_waitcnt lgkmcnt(4)
  s_waitcnt vmcnt(6)
  s_barrier
  v_mfma_f32_32x32x16_bf16 v[80:95], v[48:51], v[208:211], v[80:95]
  ds_read_b64_tr_b16 v[60:61], v11 offset:14336
  ds_read_b64_tr_b16 v[62:63], v11 offset:14848
  ds_read_b128 v[224:227], v40 offset:12288
  ds_read_b128 v[228:231], v41 offset:12288
  s_add_u32 m0, s35, 8192
  s_nop 0
  buffer_load_dwordx4 v74, s[52:55], s33 offen lds
  v_mfma_f32_16x16x32_bf16 v[20:23], v[24:27], v[48:51], v[20:23]
  v_mfma_f32_4x4x4_16b_bf16 v[28:31], v[208:209], v[208:209], v[28:31]
  v_mfma_f32_4x4x4_16b_bf16 v[32:35], v[210:211], v[210:211], v[32:35]
  v_mfma_f32_16x16x32_bf16 v[36:39], v[24:27], v[208:211], v[36:39]
  s_waitcnt lgkmcnt(6)
  v_mfma_f32_32x32x16_bf16 v[80:95], v[52:55], v[212:215], v[80:95]
  ds_read_b64_tr_b16 v[48:49], v8 offset:16384
  ds_read_b64_tr_b16 v[50:51], v8 offset:16896
  ds_read_b128 v[232:235], v42 offset:12288
  ds_read_b128 v[236:239], v43 offset:12288
  s_waitcnt lgkmcnt(8)
  v_mfma_f32_32x32x16_bf16 v[80:95], v[56:59], v[216:219], v[80:95]
  ds_read_b64_tr_b16 v[52:53], v9 offset:16384
  ds_read_b64_tr_b16 v[54:55], v9 offset:16896
  buffer_load_dwordx4 v75, s[52:55], s33 offen offset:1024 lds
  s_add_u32 s33, s33, s32
  v_mfma_f32_4x4x4_16b_bf16 v[28:31], v[216:217], v[216:217], v[28:31]
  v_mfma_f32_4x4x4_16b_bf16 v[32:35], v[218:219], v[218:219], v[32:35]
  v_mfma_f32_16x16x32_bf16 v[36:39], v[24:27], v[216:219], v[36:39]
  s_waitcnt lgkmcnt(8)
  v_mfma_f32_32x32x16_bf16 v[80:95], v[60:63], v[220:223], v[80:95]
  ds_read_b64_tr_b16 v[56:57], v10 offset:16384
  ds_read_b64_tr_b16 v[58:59], v10 offset:16896
  s_waitcnt lgkmcnt(4)
  s_waitcnt vmcnt(6)
  s_barrier
  v_mfma_f32_32x32x16_bf16 v[80:95], v[48:51], v[224:227], v[80:95]
  ds_read_b64_tr_b16 v[60:61], v11 offset:16384
  ds_read_b64_tr_b16 v[62:63], v11 offset:16896
  ds_read_b128 v[240:243], v40 offset:16384
  ds_read_b128 v[244:247], v41 offset:16384
  s_add_u32 m0, s35, 12288
  s_nop 0
  buffer_load_dwordx4 v74, s[52:55], s33 offen lds
  v_mfma_f32_16x16x32_bf16 v[20:23], v[24:27], v[48:51], v[20:23]
  v_mfma_f32_4x4x4_16b_bf16 v[28:31], v[224:225], v[224:225], v[28:31]
  v_mfma_f32_4x4x4_16b_bf16 v[32:35], v[226:227], v[226:227], v[32:35]
  v_mfma_f32_16x16x32_bf16 v[36:39], v[24:27], v[224:227], v[36:39]
  s_waitcnt lgkmcnt(6)
  v_mfma_f32_32x32x16_bf16 v[80:95], v[52:55], v[228:231], v[80:95]
  ds_read_b64_tr_b16 v[48:49], v8 offset:18432
  ds_read_b64_tr_b16 v[50:51], v8 offset:18944
  v_add_u32 v8, s34, v8
  ds_read_b128 v[248:251], v42 offset:16384
  ds_read_b128 v[252:255], v43 offset:16384
  buffer_load_dwordx4 v75, s[52:55], s33 offen offset:1024 lds
  s_add_u32 s33, s33, s32
  s_waitcnt lgkmcnt(8)
  v_mfma_f32_32x32x16_bf16 v[80:95], v[56:59], v[232:235], v[80:95]
  ds_read_b64_tr_b16 v[52:53], v9 offset:18432
  ds_read_b64_tr_b16 v[54:55], v9 offset:18944
  v_add_u32 v9, s34, v9
  s_sub_u32 m0, s35, 81920
  s_nop 0
  buffer_load_dwordx4 v7, s[12:15], s31 offen lds
  v_mfma_f32_4x4x4_16b_bf16 v[28:31], v[232:233], v[232:233], v[28:31]
  v_mfma_f32_4x4x4_16b_bf16 v[32:35], v[234:235], v[234:235], v[32:35]
  v_mfma_f32_16x16x32_bf16 v[36:39], v[24:27], v[232:235], v[36:39]
  s_waitcnt lgkmcnt(8)
  v_mfma_f32_32x32x16_bf16 v[80:95], v[60:63], v[236:239], v[80:95]
  ds_read_b64_tr_b16 v[56:57], v10 offset:18432
  ds_read_b64_tr_b16 v[58:59], v10 offset:18944
  v_add_u32 v10, s34, v10
  buffer_load_dwordx4 v6, s[12:15], s31 offen offset:1024 lds
  s_add_u32 s31, s31, 491520
  s_mul_i32 s36, s24, 15
  s_add_u32 s36, s36, s25
  s_lshl_b32 s36, s36, 3
  s_add_u32 s36, s36, s26
  s_mul_i32 s36, s36, 1280
  v_min_u32 v1, 9, v0
  v_lshlrev_b32 v1, 7, v1
  s_sub_u32 m0, s35, 73728
  s_nop 0
  buffer_load_dword v1, s[12:15], s36 offen lds
  s_waitcnt lgkmcnt(4)
  s_waitcnt vmcnt(9)
  s_barrier
  v_mfma_f32_4x4x4_16b_bf16 v[28:31], v[240:241], v[240:241], v[28:31]
  v_mfma_f32_4x4x4_16b_bf16 v[32:35], v[242:243], v[242:243], v[32:35]
  v_mfma_f32_16x16x32_bf16 v[36:39], v[24:27], v[240:243], v[36:39]
  v_mfma_f32_4x4x4_16b_bf16 v[28:31], v[248:249], v[248:249], v[28:31]
  v_mfma_f32_4x4x4_16b_bf16 v[32:35], v[250:251], v[250:251], v[32:35]
  v_mfma_f32_16x16x32_bf16 v[36:39], v[24:27], v[248:251], v[36:39]
  v_mfma_f32_32x32x16_bf16 v[80:95], v[48:51], v[240:243], v[80:95]
  ds_read_b64_tr_b16 v[60:61], v11 offset:18432
  ds_read_b64_tr_b16 v[62:63], v11 offset:18944
  v_add_u32 v11, s34, v11
  s_add_u32 m0, s35, 16384
  s_nop 0
  buffer_load_dwordx4 v74, s[52:55], s33 offen lds
  v_mfma_f32_16x16x32_bf16 v[20:23], v[24:27], v[48:51], v[20:23]
  v_and_b32 v1, 3, v0
  v_add_f32 v28, v28, v32
  v_add_f32 v29, v29, v33
  v_add_f32 v30, v30, v34
  v_add_f32 v31, v31, v35
  v_cmp_eq_u32 vcc, 1, v1
  s_nop 1
  v_cndmask_b32 v28, v28, v29, vcc
  v_cmp_eq_u32 vcc, 2, v1
  s_nop 1
  v_cndmask_b32 v28, v28, v30, vcc
  v_cmp_eq_u32 vcc, 3, v1
  s_nop 1
  v_cndmask_b32 v28, v28, v31, vcc
  v_mov_b32 v29, v36
  s_lshl_b32 s36, s26, 9
  s_add_u32 s36, s36, 32768
  v_lshlrev_b32 v1, 3, v0
  v_add_u32 v1, s36, v1
  ds_write_b64 v1, v[28:29]
  v_xor_b32 v1, 0x800, v1
  s_waitcnt lgkmcnt(5)
  v_mfma_f32_32x32x16_bf16 v[80:95], v[52:55], v[244:247], v[80:95]
  ds_read_b64_tr_b16 v[48:49], v8 offset:0
  ds_read_b64_tr_b16 v[50:51], v8 offset:512
  buffer_load_dwordx4 v75, s[52:55], s33 offen offset:1024 lds
  s_add_u32 s33, s33, s32
  s_waitcnt lgkmcnt(2)
  s_barrier
  ds_read_b64 v[30:31], v1
  v_mfma_f32_32x32x16_bf16 v[80:95], v[56:59], v[248:251], v[80:95]
  ds_write_b32 v2, v20
  v_add_u32 v2, s34, v2
  ds_read_b64_tr_b16 v[52:53], v9 offset:0
  ds_read_b64_tr_b16 v[54:55], v9 offset:512
  s_sub_u32 m0, s35, 77824
  s_nop 0
  buffer_load_dwordx4 v7, s[12:15], s31 offen lds
  v_mfma_f32_32x32x16_bf16 v[64:79], v[60:63], v[252:255], v[80:95]
  ds_read_b64_tr_b16 v[56:57], v10 offset:0
  ds_read_b64_tr_b16 v[58:59], v10 offset:512
  buffer_load_dwordx4 v6, s[12:15], s31 offen offset:1024 lds
  s_add_u32 s31, s31, 491520
  s_waitcnt lgkmcnt(5)
  s_load_dword s56, s[60:61], 0
  s_cmp_eq_u32 s47, 1
  s_cbranch_scc1 Lrare_2
  s_sub_u32 s35, s35, s34
  s_waitcnt lgkmcnt(4)
  s_waitcnt vmcnt(11)
  s_barrier
  v_mfma_f32_32x32x16_bf16 v[80:95], v[48:51], v[96:99], 0
  ds_read_b128 v[36:39], v3
  ds_read_b64_tr_b16 v[60:61], v11 offset:0
  ds_read_b64_tr_b16 v[62:63], v11 offset:512
  s_add_u32 m0, s35, 8192
  v_add_f32 v28, v28, v30
  s_mov_b32 s4, s58
  v_add_f32 v29, v29, v31
  s_and_b32 s5, s59, 0xffff
  v_mov_b32 v30, v28
  s_mov_b32 s6, 0x800000
  v_mov_b32 v31, v29
  buffer_load_dwordx4 v7, s[12:15], s31 offen lds
  v_mfma_f32_16x16x32_bf16 v[20:23], v[24:27], v[48:51], 0
  s_waitcnt lgkmcnt(5)
  v_mfma_f32_32x32x16_bf16 v[80:95], v[52:55], v[100:103], v[80:95]
  ds_read_b64_tr_b16 v[48:49], v8 offset:2048
  ds_read_b64_tr_b16 v[50:51], v8 offset:2560
  s_mov_b32 s7, 0x20000
  v_permlane32_swap_b32 v28, v30
  s_bfe_u32 s29, s2, 0x20001
  v_permlane32_swap_b32 v29, v31
  s_lshl_b32 s29, s29, 3
  v_add_f32 v28, v28, v30
  s_lshr_b32 s36, s2, 5
  s_waitcnt lgkmcnt(5)
  v_mfma_f32_32x32x16_bf16 v[80:95], v[56:59], v[104:107], v[80:95]
  ds_read_b64_tr_b16 v[52:53], v9 offset:2048
  ds_read_b64_tr_b16 v[54:55], v9 offset:2560
  v_add_f32 v29, v29, v31
  s_add_u32 s29, s29, s36
  v_mul_f32 v19, 0xbacccccd, v29
  s_lshl_b32 s29, s29, 1
  v_mul_f32 v28, 0x3acccccd, v28
  s_and_b32 s36, s2, 1
  v_fma_f32 v28, -v19, v19, v28
  s_waitcnt lgkmcnt(4)
  v_mfma_f32_32x32x16_bf16 v[80:95], v[60:63], v[108:111], v[80:95]
  ds_read_b64_tr_b16 v[56:57], v10 offset:2048
  ds_read_b64_tr_b16 v[58:59], v10 offset:2560
  v_add_f32 v36, v36, v37
  v_add_f32 v38, v38, v39
  v_add_f32 v36, v36, v38
  v_add_u32 v3, s34, v3
  s_nop 0
  v_mfma_f32_32x32x2_f32 v[64:79], v36, v19, v[64:79]
  s_sub_u32 s34, 0, s34
  s_add_u32 s29, s29, s36
  v_max_f32 v28, 0, v28
  s_lshl_b32 s29, s29, 2
  v_add_f32 v28, 0x3727c5ac, v28
  s_bfe_u32 s36, s2, 0x20003
  v_rsq_f32 v18, v28
  s_waitcnt lgkmcnt(4)
  v_mfma_f32_32x32x16_bf16 v[80:95], v[48:51], v[112:115], v[80:95]
  ds_read_b64_tr_b16 v[60:61], v11 offset:2048
  ds_read_b64_tr_b16 v[62:63], v11 offset:2560
  s_add_u32 s29, s29, s36
  v_sqrt_f32 v14, v28
  s_lshl_b32 s29, s29, 3
  v_mul_f32 v17, 0x3fb8aa3b, v18
  s_add_u32 s29, s29, s26
  v_mul_f32 v16, 0xc0135761, v18
  buffer_load_dwordx4 v6, s[12:15], s31 offen offset:1024 lds
  s_add_u32 s31, s31, 491520
  v_mfma_f32_16x16x32_bf16 v[20:23], v[24:27], v[48:51], v[20:23]
  s_waitcnt lgkmcnt(4)
  v_mfma_f32_32x32x16_bf16 v[80:95], v[52:55], v[116:119], v[80:95]
  ds_read_b64_tr_b16 v[48:49], v8 offset:4096
  ds_read_b64_tr_b16 v[50:51], v8 offset:4608
  s_lshl_b32 s29, s29, 12
  v_mul_f32 v15, v18, v18
  v_min_u32 v1, 7, v0
  v_mul_f32 v15, v15, v18
  v_lshlrev_b32 v1, 7, v1
  v_mul_f32 v15, 0xbdd2d3e8, v15
  s_waitcnt lgkmcnt(4)
  v_mfma_f32_32x32x16_bf16 v[80:95], v[56:59], v[120:123], v[80:95]
  ds_read_b64_tr_b16 v[52:53], v9 offset:4096
  ds_read_b64_tr_b16 v[54:55], v9 offset:4608
  s_waitcnt lgkmcnt(4)
  v_mfma_f32_32x32x16_bf16 v[80:95], v[60:63], v[124:127], v[80:95]
  ds_read_b64_tr_b16 v[56:57], v10 offset:4096
  ds_read_b64_tr_b16 v[58:59], v10 offset:4608
  v_mul_f32 v28, v64, v64
  v_fma_f32 v28, v28, v15, v16
  v_mul_f32 v29, v65, v65
  v_mul_f32 v28, v28, v64
  v_fma_f32 v29, v29, v15, v16
  v_mul_f32 v30, v66, v66
  s_waitcnt vmcnt(11)
  s_barrier
  s_waitcnt lgkmcnt(4)
  v_mfma_f32_32x32x16_bf16 v[80:95], v[48:51], v[128:131], v[80:95]
  ds_read_b64_tr_b16 v[60:61], v11 offset:4096
  ds_read_b64_tr_b16 v[62:63], v11 offset:4608
  s_add_u32 m0, s35, 12288
  v_exp_f32 v28, v28
  v_mul_f32 v29, v29, v65
  v_fma_f32 v30, v30, v15, v16
  v_mul_f32 v31, v67, v67
  v_fma_f32 v28, v28, v14, v14
  v_exp_f32 v29, v29
  buffer_load_dwordx4 v7, s[12:15], s31 offen lds
  v_mfma_f32_16x16x32_bf16 v[20:23], v[24:27], v[48:51], v[20:23]
  s_waitcnt lgkmcnt(4)
  v_mfma_f32_32x32x16_bf16 v[80:95], v[52:55], v[132:135], v[80:95]
  ds_read_b64_tr_b16 v[48:49], v8 offset:6144
  ds_read_b64_tr_b16 v[50:51], v8 offset:6656
  v_mul_f32 v30, v30, v66
  v_fma_f32 v31, v31, v15, v16
  v_mul_f32 v32, v68, v68
  v_rcp_f32 v28, v28
  v_fma_f32 v29, v29, v14, v14
  v_exp_f32 v30, v30
  s_waitcnt lgkmcnt(4)
  v_mfma_f32_32x32x16_bf16 v[80:95], v[56:59], v[136:139], v[80:95]
  ds_read_b64_tr_b16 v[52:53], v9 offset:6144
  ds_read_b64_tr_b16 v[54:55], v9 offset:6656
  v_mul_f32 v31, v31, v67
  v_fma_f32 v32, v32, v15, v16
  v_mul_f32 v33, v69, v69
  v_mul_f32 v64, v64, v28
  v_rcp_f32 v29, v29
  v_fma_f32 v30, v30, v14, v14
  s_waitcnt lgkmcnt(4)
  v_mfma_f32_32x32x16_bf16 v[80:95], v[60:63], v[140:143], v[80:95]
  ds_read_b64_tr_b16 v[56:57], v10 offset:6144
  ds_read_b64_tr_b16 v[58:59], v10 offset:6656
  v_exp_f32 v31, v31
  v_mul_f32 v32, v32, v68
  v_fma_f32 v33, v33, v15, v16
  v_mul_f32 v34, v70, v70
  v_mul_f32 v65, v65, v29
  v_rcp_f32 v30, v30
  s_waitcnt lgkmcnt(4)
  v_mfma_f32_32x32x16_bf16 v[80:95], v[48:51], v[144:147], v[80:95]
  ds_read_b64_tr_b16 v[60:61], v11 offset:6144
  ds_read_b64_tr_b16 v[62:63], v11 offset:6656
  v_fma_f32 v31, v31, v14, v14
  v_exp_f32 v32, v32
  v_mul_f32 v33, v33, v69
  v_fma_f32 v34, v34, v15, v16
  v_mul_f32 v35, v71, v71
  v_cvt_pk_bf16_f32 v40, v64, v65
  buffer_load_dwordx4 v6, s[12:15], s31 offen offset:1024 lds
  s_add_u32 s31, s31, 491520
  v_mfma_f32_16x16x32_bf16 v[20:23], v[24:27], v[48:51], v[20:23]
  s_waitcnt lgkmcnt(4)
  v_mfma_f32_32x32x16_bf16 v[80:95], v[52:55], v[148:151], v[80:95]
  ds_read_b64_tr_b16 v[48:49], v8 offset:8192
  ds_read_b64_tr_b16 v[50:51], v8 offset:8704
  v_mul_f32 v66, v66, v30
  v_rcp_f32 v31, v31
  v_fma_f32 v32, v32, v14, v14
  v_exp_f32 v33, v33
  v_mul_f32 v34, v34, v70
  v_fma_f32 v35, v35, v15, v16
  s_waitcnt lgkmcnt(4)
  v_mfma_f32_32x32x16_bf16 v[80:95], v[56:59], v[152:155], v[80:95]
  ds_read_b64_tr_b16 v[52:53], v9 offset:8192
  ds_read_b64_tr_b16 v[54:55], v9 offset:8704
  v_mul_f32 v28, v72, v72
  v_dot2c_f32_bf16 v12, s39, v40
  v_mul_f32 v67, v67, v31
  v_rcp_f32 v32, v32
  v_fma_f32 v33, v33, v14, v14
  v_exp_f32 v34, v34
  s_waitcnt lgkmcnt(4)
  v_mfma_f32_32x32x16_bf16 v[80:95], v[60:63], v[156:159], v[80:95]
  ds_read_b64_tr_b16 v[56:57], v10 offset:8192
  ds_read_b64_tr_b16 v[58:59], v10 offset:8704
  v_mul_f32 v35, v35, v71
  v_fma_f32 v28, v28, v15, v16
  v_mul_f32 v29, v73, v73
  v_dot2c_f32_bf16 v13, v40, v40
  v_cvt_pk_bf16_f32 v41, v66, v67
  v_mul_f32 v68, v68, v32
  s_waitcnt vmcnt(11)
  s_barrier
  s_waitcnt lgkmcnt(4)
  v_mfma_f32_32x32x16_bf16 v[80:95], v[48:51], v[160:163], v[80:95]
  ds_read_b64_tr_b16 v[60:61], v11 offset:8192
  ds_read_b64_tr_b16 v[62:63], v11 offset:8704
  s_add_u32 m0, s35, 16384
  v_rcp_f32 v33, v33
  v_fma_f32 v34, v34, v14, v14
  v_exp_f32 v35, v35
  v_mul_f32 v28, v28, v72
  v_fma_f32 v29, v29, v15, v16
  v_mul_f32 v30, v74, v74
  buffer_load_dword v1, s[4:7], s29 offen lds
  s_add_u32 s29, s29, 1024
  buffer_load_dwordx4 v7, s[12:15], s31 offen lds
  v_mfma_f32_16x16x32_bf16 v[20:23], v[24:27], v[48:51], v[20:23]
  s_waitcnt lgkmcnt(4)
  v_mfma_f32_32x32x16_bf16 v[80:95], v[52:55], v[164:167], v[80:95]
  ds_read_b64_tr_b16 v[48:49], v8 offset:10240
  ds_read_b64_tr_b16 v[50:51], v8 offset:10752
  v_dot2c_f32_bf16 v12, s39, v41
  v_mul_f32 v69, v69, v33
  v_rcp_f32 v34, v34
  v_fma_f32 v35, v35, v14, v14
  v_exp_f32 v28, v28
  v_mul_f32 v29, v29, v73
  s_waitcnt lgkmcnt(4)
  v_mfma_f32_32x32x16_bf16 v[80:95], v[56:59], v[168:171], v[80:95]
  ds_read_b64_tr_b16 v[52:53], v9 offset:10240
  ds_read_b64_tr_b16 v[54:55], v9 offset:10752
  v_fma_f32 v30, v30, v15, v16
  v_mul_f32 v31, v75, v75
  v_dot2c_f32_bf16 v13, v41, v41
  v_cvt_pk_bf16_f32 v42, v68, v69
  v_mul_f32 v70, v70, v34
  v_rcp_f32 v35, v35
  s_waitcnt lgkmcnt(4)
  v_mfma_f32_32x32x16_bf16 v[80:95], v[60:63], v[172:175], v[80:95]
  ds_read_b64_tr_b16 v[56:57], v10 offset:10240
  ds_read_b64_tr_b16 v[58:59], v10 offset:10752
  v_fma_f32 v28, v28, v14, v14
  v_exp_f32 v29, v29
  v_mul_f32 v30, v30, v74
  v_fma_f32 v31, v31, v15, v16
  v_mul_f32 v32, v76, v76
  v_dot2c_f32_bf16 v12, s39, v42
  s_waitcnt lgkmcnt(4)
  v_mfma_f32_32x32x16_bf16 v[80:95], v[48:51], v[176:179], v[80:95]
  ds_read_b64_tr_b16 v[60:61], v11 offset:10240
  ds_read_b64_tr_b16 v[62:63], v11 offset:10752
  v_mul_f32 v71, v71, v35
  v_rcp_f32 v28, v28
  v_fma_f32 v29, v29, v14, v14
  v_exp_f32 v30, v30
  v_mul_f32 v31, v31, v75
  v_fma_f32 v32, v32, v15, v16
  buffer_load_dwordx4 v6, s[12:15], s31 offen offset:1024 lds
  s_add_u32 s31, s31, 4293001344
  s_sub_u32 s35, s35, s34
  v_mfma_f32_16x16x32_bf16 v[20:23], v[24:27], v[48:51], v[20:23]
  s_waitcnt lgkmcnt(4)
  v_mfma_f32_32x32x16_bf16 v[80:95], v[52:55], v[180:183], v[80:95]
  ds_read_b64_tr_b16 v[48:49], v8 offset:12288
  ds_read_b64_tr_b16 v[50:51], v8 offset:12800
  v_mul_f32 v33, v77, v77
  v_dot2c_f32_bf16 v13, v42, v42
  v_cvt_pk_bf16_f32 v43, v70, v71
  v_mul_f32 v72, v72, v28
  v_rcp_f32 v29, v29
  v_fma_f32 v30, v30, v14, v14
  s_waitcnt lgkmcnt(4)
  v_mfma_f32_32x32x16_bf16 v[80:95], v[56:59], v[184:187], v[80:95]
  ds_read_b64_tr_b16 v[52:53], v9 offset:12288
  ds_read_b64_tr_b16 v[54:55], v9 offset:12800
  v_exp_f32 v31, v31
  v_mul_f32 v32, v32, v76
  v_fma_f32 v33, v33, v15, v16
  v_mul_f32 v34, v78, v78
  v_dot2c_f32_bf16 v12, s39, v43
  v_mul_f32 v73, v73, v29
  s_waitcnt lgkmcnt(4)
  v_mfma_f32_32x32x16_bf16 v[80:95], v[60:63], v[188:191], v[80:95]
  ds_read_b64_tr_b16 v[56:57], v10 offset:12288
  ds_read_b64_tr_b16 v[58:59], v10 offset:12800
  v_rcp_f32 v30, v30
  v_fma_f32 v31, v31, v14, v14
  v_exp_f32 v32, v32
  v_mul_f32 v33, v33, v77
  v_fma_f32 v34, v34, v15, v16
  v_mul_f32 v35, v79, v79
  s_waitcnt vmcnt(9)
  s_barrier
  s_waitcnt lgkmcnt(4)
  v_mfma_f32_32x32x16_bf16 v[80:95], v[48:51], v[192:195], v[80:95]
  ds_read_b64_tr_b16 v[60:61], v11 offset:12288
  ds_read_b64_tr_b16 v[62:63], v11 offset:12800
  s_add_u32 m0, s35, 0
  v_dot2c_f32_bf16 v13, v43, v43
  v_cvt_pk_bf16_f32 v44, v72, v73
  v_mul_f32 v74, v74, v30
  v_rcp_f32 v31, v31
  v_fma_f32 v32, v32, v14, v14
  v_exp_f32 v33, v33
  buffer_load_dwordx4 v7, s[12:15], s31 offen lds
  v_mfma_f32_16x16x32_bf16 v[20:23], v[24:27], v[48:51], v[20:23]
  s_waitcnt lgkmcnt(4)
  v_mfma_f32_32x32x16_bf16 v[80:95], v[52:55], v[196:199], v[80:95]
  ds_read_b64_tr_b16 v[48:49], v8 offset:14336
  ds_read_b64_tr_b16 v[50:51], v8 offset:14848
  v_mul_f32 v34, v34, v78
  v_fma_f32 v35, v35, v15, v16
  buffer_store_dwordx4 v[40:43], v5, s[16:19], s43 offen sc1
  v_dot2c_f32_bf16 v12, s39, v44
  v_mul_f32 v75, v75, v31
  s_waitcnt lgkmcnt(4)
  v_mfma_f32_32x32x16_bf16 v[80:95], v[56:59], v[200:203], v[80:95]
  ds_read_b64_tr_b16 v[52:53], v9 offset:14336
  ds_read_b64_tr_b16 v[54:55], v9 offset:14848
  v_rcp_f32 v32, v32
  v_fma_f32 v33, v33, v14, v14
  v_exp_f32 v34, v34
  v_mul_f32 v35, v35, v79
  v_dot2c_f32_bf16 v13, v44, v44
  s_waitcnt lgkmcnt(4)
  v_mfma_f32_32x32x16_bf16 v[80:95], v[60:63], v[204:207], v[80:95]
  ds_read_b64_tr_b16 v[56:57], v10 offset:14336
  ds_read_b64_tr_b16 v[58:59], v10 offset:14848
  v_cvt_pk_bf16_f32 v45, v74, v75
  v_mul_f32 v76, v76, v32
  v_rcp_f32 v33, v33
  v_fma_f32 v34, v34, v14, v14
  v_exp_f32 v35, v35
  s_waitcnt lgkmcnt(4)
  v_mfma_f32_32x32x16_bf16 v[80:95], v[48:51], v[208:211], v[80:95]
  ds_read_b64_tr_b16 v[60:61], v11 offset:14336
  ds_read_b64_tr_b16 v[62:63], v11 offset:14848
  v_dot2c_f32_bf16 v12, s39, v45
  v_mul_f32 v77, v77, v33
  v_rcp_f32 v34, v34
  v_fma_f32 v35, v35, v14, v14
  v_dot2c_f32_bf16 v13, v45, v45
  buffer_load_dwordx4 v6, s[12:15], s31 offen offset:1024 lds
  s_add_u32 s31, s31, 491520
  v_mfma_f32_16x16x32_bf16 v[20:23], v[24:27], v[48:51], v[20:23]
  s_waitcnt lgkmcnt(4)
  v_mfma_f32_32x32x16_bf16 v[80:95], v[52:55], v[212:215], v[80:95]
  ds_read_b64_tr_b16 v[48:49], v8 offset:16384
  ds_read_b64_tr_b16 v[50:51], v8 offset:16896
  v_cvt_pk_bf16_f32 v46, v76, v77
  v_mul_f32 v78, v78, v34
  v_rcp_f32 v35, v35
  v_dot2c_f32_bf16 v12, s39, v46
  v_mul_f32 v79, v79, v35
  s_waitcnt lgkmcnt(4)
  v_mfma_f32_32x32x16_bf16 v[80:95], v[56:59], v[216:219], v[80:95]
  ds_read_b64_tr_b16 v[52:53], v9 offset:16384
  ds_read_b64_tr_b16 v[54:55], v9 offset:16896
  v_dot2c_f32_bf16 v13, v46, v46
  v_cvt_pk_bf16_f32 v47, v78, v79
  v_dot2c_f32_bf16 v12, s39, v47
  v_dot2c_f32_bf16 v13, v47, v47
  buffer_store_dwordx4 v[44:47], v4, s[16:19], s43 offen sc1
  s_lshl_b32 s36, s26, 9
  s_add_u32 s36, s36, 110592
  v_lshlrev_b32 v30, 3, v0
  v_add_u32 v30, s36, v30
  v_mul_f32 v12, s45, v12
  v_mul_f32 v13, s45, v13
  v_mov_b32 v28, v12
  v_mov_b32 v29, v13
  s_nop 0
  v_permlane32_swap_b32 v12, v28
  v_permlane32_swap_b32 v13, v29
  v_add_f32 v12, v12, v28
  v_add_f32 v13, v13, v29
  ds_write_b64 v30, v[12:13]
  s_waitcnt lgkmcnt(5)
  v_mfma_f32_32x32x16_bf16 v[80:95], v[60:63], v[220:223], v[80:95]
  ds_read_b64_tr_b16 v[56:57], v10 offset:16384
  ds_read_b64_tr_b16 v[58:59], v10 offset:16896
  s_waitcnt lgkmcnt(2)
  s_waitcnt vmcnt(16)
  s_barrier
  v_mfma_f32_32x32x16_bf16 v[80:95], v[48:51], v[224:227], v[80:95]
  ds_read_b64_tr_b16 v[60:61], v11 offset:16384
  ds_read_b64_tr_b16 v[62:63], v11 offset:16896
  s_add_u32 m0, s35, 4096
  s_nop 0
  buffer_load_dwordx4 v7, s[12:15], s31 offen lds
  v_mfma_f32_16x16x32_bf16 v[20:23], v[24:27], v[48:51], v[20:23]
  v_xor_b32 v30, 0x800, v30
  ds_read_b64 v[32:33], v30
  v_lshlrev_b32 v28, 3, v0
  v_mfma_f32_32x32x16_bf16 v[80:95], v[52:55], v[228:231], v[80:95]
  ds_read_b64_tr_b16 v[48:49], v8 offset:18432
  ds_read_b64_tr_b16 v[50:51], v8 offset:18944
  v_add_u32 v8, s34, v8
  s_waitcnt lgkmcnt(5)
  v_mfma_f32_32x32x16_bf16 v[80:95], v[56:59], v[232:235], v[80:95]
  ds_read_b64_tr_b16 v[52:53], v9 offset:18432
  ds_read_b64_tr_b16 v[54:55], v9 offset:18944
  v_add_u32 v9, s34, v9
  s_waitcnt lgkmcnt(0)
  s_cmp_lg_u32 s56, 16
  s_cbranch_scc1 Lrare_4
Lback_5:
  v_add_f32 v12, v12, v32
  v_add_f32 v13, v13, v33
  v_or_b32 v13, 0x80000000, v13
  s_mov_b32 exec_hi, 0
  buffer_store_dwordx2 v[12:13], v28, s[16:19], s57 offen sc1
  s_mov_b64 exec, -1
  v_mfma_f32_32x32x16_bf16 v[80:95], v[60:63], v[236:239], v[80:95]
  ds_read_b64_tr_b16 v[56:57], v10 offset:18432
  ds_read_b64_tr_b16 v[58:59], v10 offset:18944
  v_add_u32 v10, s34, v10
  v_mfma_f32_32x32x16_bf16 v[80:95], v[48:51], v[240:243], v[80:95]
  ds_read_b64_tr_b16 v[60:61], v11 offset:18432
  ds_read_b64_tr_b16 v[62:63], v11 offset:18944
  v_add_u32 v11, s34, v11
  buffer_load_dwordx4 v6, s[12:15], s31 offen offset:1024 lds
  s_add_u32 s31, s31, 491520
  v_mfma_f32_16x16x32_bf16 v[20:23], v[24:27], v[48:51], v[20:23]
  v_mfma_f32_32x32x16_bf16 v[80:95], v[52:55], v[244:247], v[80:95]
  ds_read_b64_tr_b16 v[48:49], v8 offset:0
  ds_read_b64_tr_b16 v[50:51], v8 offset:512
  s_waitcnt lgkmcnt(4)
  v_mfma_f32_32x32x16_bf16 v[80:95], v[56:59], v[248:251], v[80:95]
  s_nop 2
  ds_write_b32 v2, v20
  v_subrev_u32 v2, 81920, v2
  ds_read_b64_tr_b16 v[52:53], v9 offset:0
  ds_read_b64_tr_b16 v[54:55], v9 offset:512
  s_waitcnt lgkmcnt(5)
  v_mfma_f32_32x32x16_bf16 v[64:79], v[60:63], v[252:255], v[80:95]
  ds_read_b64_tr_b16 v[56:57], v10 offset:0
  ds_read_b64_tr_b16 v[58:59], v10 offset:512
  s_mov_b32 s43, s64
  s_mov_b32 s64, s3
  s_add_u32 s3, s3, 4096
  s_cmp_ge_u32 s71, 20
  s_mov_b32 s40, 0x358637bd
  s_cselect_b32 s40, 0xff800000, s40
  s_cselect_b32 s41, 0, 1.0
  s_cselect_b32 s42, 0, 0x358637bd
  s_add_u32 s71, s71, 1
  s_cmp_eq_u32 s46, 0
  s_cbranch_scc1 K1_bodyP
  s_waitcnt lgkmcnt(4)
  s_waitcnt vmcnt(14)
  s_barrier
  v_mfma_f32_32x32x16_bf16 v[80:95], v[48:51], v[96:99], 0
  ds_read_b128 v[36:39], v3
  ds_read_b64_tr_b16 v[60:61], v11 offset:0
  ds_read_b64_tr_b16 v[62:63], v11 offset:512
  s_add_u32 m0, s35, 8192
  s_nop 0
  buffer_load_dword v1, s[4:7], s29 offen lds
  s_add_u32 s29, s29, 1024
  buffer_load_dwordx4 v7, s[12:15], s31 offen lds
  v_mfma_f32_16x16x32_bf16 v[20:23], v[24:27], v[48:51], 0
  s_waitcnt lgkmcnt(5)
  v_mfma_f32_32x32x16_bf16 v[80:95], v[52:55], v[100:103], v[80:95]
  ds_read_b64_tr_b16 v[48:49], v8 offset:2048
  ds_read_b64_tr_b16 v[50:51], v8 offset:2560
  v_lshlrev_b32 v1, 3, v0
  s_waitcnt lgkmcnt(5)
  v_mfma_f32_32x32x16_bf16 v[80:95], v[56:59], v[104:107], v[80:95]
  ds_read_b64_tr_b16 v[52:53], v9 offset:2048
  ds_read_b64_tr_b16 v[54:55], v9 offset:2560
  s_waitcnt lgkmcnt(6)
  v_add_f32 v36, v36, v37
  v_add_f32 v38, v38, v39
  v_add_f32 v36, v36, v38
  v_add_u32 v3, s34, v3
  s_nop 0
  v_mfma_f32_32x32x2_f32 v[64:79], v36, v19, v[64:79]
  s_sub_u32 s34, 0, s34
  s_waitcnt lgkmcnt(4)
  v_mfma_f32_32x32x16_bf16 v[80:95], v[60:63], v[108:111], v[80:95]
  ds_read_b64_tr_b16 v[56:57], v10 offset:2048
  ds_read_b64_tr_b16 v[58:59], v10 offset:2560
  s_waitcnt lgkmcnt(4)
  v_mfma_f32_32x32x16_bf16 v[80:95], v[48:51], v[112:115], v[80:95]
  ds_read_b64_tr_b16 v[60:61], v11 offset:2048
  ds_read_b64_tr_b16 v[62:63], v11 offset:2560
  buffer_load_dwordx4 v6, s[12:15], s31 offen offset:1024 lds
  s_add_u32 s31, s31, 491520
  v_mfma_f32_16x16x32_bf16 v[20:23], v[24:27], v[48:51], v[20:23]
  s_waitcnt lgkmcnt(4)
  v_mfma_f32_32x32x16_bf16 v[80:95], v[52:55], v[116:119], v[80:95]
  ds_read_b64_tr_b16 v[48:49], v8 offset:4096
  ds_read_b64_tr_b16 v[50:51], v8 offset:4608
  s_waitcnt lgkmcnt(4)
  v_mfma_f32_32x32x16_bf16 v[80:95], v[56:59], v[120:123], v[80:95]
  ds_read_b64_tr_b16 v[52:53], v9 offset:4096
  ds_read_b64_tr_b16 v[54:55], v9 offset:4608
  v_mul_f32 v28, v64, v64
  v_fma_f32 v28, v28, v15, v16
  v_mul_f32 v29, v65, v65
  v_mul_f32 v28, v28, v64
  s_waitcnt lgkmcnt(4)
  v_mfma_f32_32x32x16_bf16 v[80:95], v[60:63], v[124:127], v[80:95]
  ds_read_b64_tr_b16 v[56:57], v10 offset:4096
  ds_read_b64_tr_b16 v[58:59], v10 offset:4608
  v_fma_f32 v29, v29, v15, v16
  v_mul_f32 v30, v66, v66
  v_exp_f32 v28, v28
  v_mul_f32 v29, v29, v65
  s_waitcnt vmcnt(15)
  s_barrier
  s_waitcnt lgkmcnt(4)
  v_mfma_f32_32x32x16_bf16 v[80:95], v[48:51], v[128:131], v[80:95]
  ds_read_b64_tr_b16 v[60:61], v11 offset:4096
  ds_read_b64_tr_b16 v[62:63], v11 offset:4608
  s_add_u32 m0, s35, 12288
  v_fma_f32 v30, v30, v15, v16
  v_mul_f32 v31, v67, v67
  v_fma_f32 v28, v28, v14, v14
  v_exp_f32 v29, v29
  buffer_load_dwordx4 v7, s[12:15], s31 offen lds
  v_mfma_f32_16x16x32_bf16 v[20:23], v[24:27], v[48:51], v[20:23]
  s_waitcnt lgkmcnt(4)
  v_mfma_f32_32x32x16_bf16 v[80:95], v[52:55], v[132:135], v[80:95]
  ds_read_b64_tr_b16 v[48:49], v8 offset:6144
  ds_read_b64_tr_b16 v[50:51], v8 offset:6656
  v_mul_f32 v30, v30, v66
  v_fma_f32 v31, v31, v15, v16
  v_mul_f32 v32, v68, v68
  v_rcp_f32 v28, v28
  s_waitcnt lgkmcnt(4)
  v_mfma_f32_32x32x16_bf16 v[80:95], v[56:59], v[136:139], v[80:95]
  ds_read_b64_tr_b16 v[52:53], v9 offset:6144
  ds_read_b64_tr_b16 v[54:55], v9 offset:6656
  v_fma_f32 v29, v29, v14, v14
  v_exp_f32 v30, v30
  v_mul_f32 v31, v31, v67
  v_fma_f32 v32, v32, v15, v16
  s_waitcnt lgkmcnt(4)
  v_mfma_f32_32x32x16_bf16 v[80:95], v[60:63], v[140:143], v[80:95]
  ds_read_b64_tr_b16 v[56:57], v10 offset:6144
  ds_read_b64_tr_b16 v[58:59], v10 offset:6656
  v_mul_f32 v33, v69, v69
  v_mul_f32 v64, v64, v28
  v_rcp_f32 v29, v29
  v_fma_f32 v30, v30, v14, v14
  s_waitcnt lgkmcnt(4)
  v_mfma_f32_32x32x16_bf16 v[80:95], v[48:51], v[144:147], v[80:95]
  ds_read_b64_tr_b16 v[60:61], v11 offset:6144
  ds_read_b64_tr_b16 v[62:63], v11 offset:6656
  v_exp_f32 v31, v31
  v_mul_f32 v32, v32, v68
  v_fma_f32 v33, v33, v15, v16
  v_mul_f32 v34, v70, v70
  buffer_load_dwordx4 v6, s[12:15], s31 offen offset:1024 lds
  s_add_u32 s31, s31, 491520
  v_mfma_f32_16x16x32_bf16 v[20:23], v[24:27], v[48:51], v[20:23]
  s_waitcnt lgkmcnt(4)
  v_mfma_f32_32x32x16_bf16 v[80:95], v[52:55], v[148:151], v[80:95]
  ds_read_b64_tr_b16 v[48:49], v8 offset:8192
  ds_read_b64_tr_b16 v[50:51], v8 offset:8704
  v_mul_f32 v65, v65, v29
  v_rcp_f32 v30, v30
  v_fma_f32 v31, v31, v14, v14
  v_exp_f32 v32, v32
  s_waitcnt lgkmcnt(4)
  v_mfma_f32_32x32x16_bf16 v[80:95], v[56:59], v[152:155], v[80:95]
  ds_read_b64_tr_b16 v[52:53], v9 offset:8192
  ds_read_b64_tr_b16 v[54:55], v9 offset:8704
  v_mul_f32 v33, v33, v69
  v_fma_f32 v34, v34, v15, v16
  v_mul_f32 v35, v71, v71
  v_cvt_pk_bf16_f32 v36, v64, v65
  s_waitcnt lgkmcnt(4)
  v_mfma_f32_32x32x16_bf16 v[80:95], v[60:63], v[156:159], v[80:95]
  ds_read_b64_tr_b16 v[56:57], v10 offset:8192
  ds_read_b64_tr_b16 v[58:59], v10 offset:8704
  v_mul_f32 v66, v66, v30
  v_rcp_f32 v31, v31
  v_fma_f32 v32, v32, v14, v14
  v_exp_f32 v33, v33
  s_waitcnt vmcnt(15)
  s_barrier
  s_waitcnt lgkmcnt(4)
  v_mfma_f32_32x32x16_bf16 v[80:95], v[48:51], v[160:163], v[80:95]
  ds_read_b64_tr_b16 v[60:61], v11 offset:8192
  ds_read_b64_tr_b16 v[62:63], v11 offset:8704
  s_add_u32 m0, s35, 16384
  v_mul_f32 v34, v34, v70
  v_fma_f32 v35, v35, v15, v16
  v_mul_f32 v28, v72, v72
  v_mul_f32 v67, v67, v31
  buffer_load_dwordx4 v7, s[12:15], s31 offen lds
  v_mfma_f32_16x16x32_bf16 v[20:23], v[24:27], v[48:51], v[20:23]
  s_waitcnt lgkmcnt(4)
  v_mfma_f32_32x32x16_bf16 v[80:95], v[52:55], v[164:167], v[80:95]
  ds_read_b64_tr_b16 v[48:49], v8 offset:10240
  ds_read_b64_tr_b16 v[50:51], v8 offset:10752
  v_rcp_f32 v32, v32
  v_fma_f32 v33, v33, v14, v14
  v_exp_f32 v34, v34
  v_mul_f32 v35, v35, v71
  s_waitcnt lgkmcnt(4)
  v_mfma_f32_32x32x16_bf16 v[80:95], v[56:59], v[168:171], v[80:95]
  ds_read_b64_tr_b16 v[52:53], v9 offset:10240
  ds_read_b64_tr_b16 v[54:55], v9 offset:10752
  v_fma_f32 v28, v28, v15, v16
  v_mul_f32 v29, v73, v73
  v_cvt_pk_bf16_f32 v37, v66, v67
  v_mul_f32 v68, v68, v32
  s_waitcnt lgkmcnt(4)
  v_mfma_f32_32x32x16_bf16 v[80:95], v[60:63], v[172:175], v[80:95]
  ds_read_b64_tr_b16 v[56:57], v10 offset:10240
  ds_read_b64_tr_b16 v[58:59], v10 offset:10752
  v_rcp_f32 v33, v33
  v_fma_f32 v34, v34, v14, v14
  v_exp_f32 v35, v35
  v_mul_f32 v28, v28, v72
  s_waitcnt lgkmcnt(4)
  v_mfma_f32_32x32x16_bf16 v[80:95], v[48:51], v[176:179], v[80:95]
  ds_read_b64_tr_b16 v[60:61], v11 offset:10240
  ds_read_b64_tr_b16 v[62:63], v11 offset:10752
  v_fma_f32 v29, v29, v15, v16
  v_mul_f32 v30, v74, v74
  v_mul_f32 v69, v69, v33
  v_rcp_f32 v34, v34
  buffer_load_dwordx4 v6, s[12:15], s31 offen offset:1024 lds
  s_add_u32 s31, s31, 4293001344
  s_sub_u32 s35, s35, s34
  v_mfma_f32_16x16x32_bf16 v[20:23], v[24:27], v[48:51], v[20:23]
  s_waitcnt lgkmcnt(4)
  v_mfma_f32_32x32x16_bf16 v[80:95], v[52:55], v[180:183], v[80:95]
  ds_read_b64_tr_b16 v[48:49], v8 offset:12288
  ds_read_b64_tr_b16 v[50:51], v8 offset:12800
  v_fma_f32 v35, v35, v14, v14
  v_exp_f32 v28, v28
  v_mul_f32 v29, v29, v73
  v_fma_f32 v30, v30, v15, v16
  s_waitcnt lgkmcnt(4)
  v_mfma_f32_32x32x16_bf16 v[80:95], v[56:59], v[184:187], v[80:95]
  ds_read_b64_tr_b16 v[52:53], v9 offset:12288
  ds_read_b64_tr_b16 v[54:55], v9 offset:12800
  v_mul_f32 v31, v75, v75
  v_cvt_pk_bf16_f32 v38, v68, v69
  v_mul_f32 v70, v70, v34
  v_rcp_f32 v35, v35
  s_waitcnt lgkmcnt(4)
  v_mfma_f32_32x32x16_bf16 v[80:95], v[60:63], v[188:191], v[80:95]
  ds_read_b64_tr_b16 v[56:57], v10 offset:12288
  ds_read_b64_tr_b16 v[58:59], v10 offset:12800
  v_fma_f32 v28, v28, v14, v14
  v_exp_f32 v29, v29
  v_mul_f32 v30, v30, v74
  v_fma_f32 v31, v31, v15, v16
  s_waitcnt vmcnt(14)
  s_barrier
  s_waitcnt lgkmcnt(4)
  v_mfma_f32_32x32x16_bf16 v[80:95], v[48:51], v[192:195], v[80:95]
  ds_read_b64_tr_b16 v[60:61], v11 offset:12288
  ds_read_b64_tr_b16 v[62:63], v11 offset:12800
  s_mov_b32 m0, s70
  v_lshlrev_b32 v12, 4, v0
  s_and_b32 s36, s66, 0xfffff000
  s_lshl_b32 s67, s28, 11
  s_add_u32 s36, s36, s67
  buffer_load_dwordx4 v12, s[16:19], s36 offen sc1 lds
  v_mul_f32 v32, v76, v76
  v_mul_f32 v71, v71, v35
  v_rcp_f32 v28, v28
  v_fma_f32 v29, v29, v14, v14
  v_mfma_f32_16x16x32_bf16 v[20:23], v[24:27], v[48:51], v[20:23]
  s_waitcnt lgkmcnt(4)
  v_mfma_f32_32x32x16_bf16 v[80:95], v[52:55], v[196:199], v[80:95]
  ds_read_b64_tr_b16 v[48:49], v8 offset:14336
  ds_read_b64_tr_b16 v[50:51], v8 offset:14848
  v_exp_f32 v30, v30
  v_mul_f32 v31, v31, v75
  v_fma_f32 v32, v32, v15, v16
  v_mul_f32 v33, v77, v77
  s_waitcnt lgkmcnt(4)
  v_mfma_f32_32x32x16_bf16 v[80:95], v[56:59], v[200:203], v[80:95]
  ds_read_b64_tr_b16 v[52:53], v9 offset:14336
  ds_read_b64_tr_b16 v[54:55], v9 offset:14848
  v_cvt_pk_bf16_f32 v39, v70, v71
  v_mul_f32 v72, v72, v28
  v_rcp_f32 v29, v29
  v_fma_f32 v30, v30, v14, v14
  s_waitcnt lgkmcnt(4)
  v_mfma_f32_32x32x16_bf16 v[80:95], v[60:63], v[204:207], v[80:95]
  ds_read_b64_tr_b16 v[56:57], v10 offset:14336
  ds_read_b64_tr_b16 v[58:59], v10 offset:14848
  v_exp_f32 v31, v31
  v_mul_f32 v32, v32, v76
  v_fma_f32 v33, v33, v15, v16
  v_mul_f32 v34, v78, v78
  s_waitcnt lgkmcnt(4)
  v_mfma_f32_32x32x16_bf16 v[80:95], v[48:51], v[208:211], v[80:95]
  ds_read_b64_tr_b16 v[60:61], v11 offset:14336
  ds_read_b64_tr_b16 v[62:63], v11 offset:14848
  buffer_load_dwordx4 v12, s[16:19], s36 offen offset:1024 sc1 lds
  buffer_store_dwordx4 v[36:39], v5, s[16:19], s43 offen sc1
  v_mul_f32 v73, v73, v29
  v_rcp_f32 v30, v30
  v_fma_f32 v31, v31, v14, v14
  v_mfma_f32_16x16x32_bf16 v[20:23], v[24:27], v[48:51], v[20:23]
  s_waitcnt lgkmcnt(4)
  v_mfma_f32_32x32x16_bf16 v[80:95], v[52:55], v[212:215], v[80:95]
  ds_read_b64_tr_b16 v[48:49], v8 offset:16384
  ds_read_b64_tr_b16 v[50:51], v8 offset:16896
  v_exp_f32 v32, v32
  v_mul_f32 v33, v33, v77
  v_fma_f32 v34, v34, v15, v16
  s_waitcnt lgkmcnt(4)
  v_mfma_f32_32x32x16_bf16 v[80:95], v[56:59], v[216:219], v[80:95]
  ds_read_b64_tr_b16 v[52:53], v9 offset:16384
  ds_read_b64_tr_b16 v[54:55], v9 offset:16896
  v_mul_f32 v35, v79, v79
  v_cvt_pk_bf16_f32 v36, v72, v73
  v_mul_f32 v74, v74, v30
  s_waitcnt lgkmcnt(4)
  v_mfma_f32_32x32x16_bf16 v[80:95], v[60:63], v[220:223], v[80:95]
  ds_read_b64_tr_b16 v[56:57], v10 offset:16384
  ds_read_b64_tr_b16 v[58:59], v10 offset:16896
  v_rcp_f32 v31, v31
  v_fma_f32 v32, v32, v14, v14
  v_exp_f32 v33, v33
  s_waitcnt vmcnt(14)
  s_barrier
  s_waitcnt lgkmcnt(4)
  v_mfma_f32_32x32x16_bf16 v[80:95], v[48:51], v[224:227], v[80:95]
  ds_read_b64_tr_b16 v[60:61], v11 offset:16384
  ds_read_b64_tr_b16 v[62:63], v11 offset:16896
  v_mul_f32 v34, v34, v78
  v_fma_f32 v35, v35, v15, v16
  v_mul_f32 v75, v75, v31
  s_bfe_u32 s32, s2, 0x20001
  s_lshl_b32 s32, s32, 3
  s_lshr_b32 s33, s2, 5
  s_add_u32 s32, s32, s33
  v_mfma_f32_16x16x32_bf16 v[20:23], v[24:27], v[48:51], v[20:23]
  s_waitcnt lgkmcnt(4)
  v_mfma_f32_32x32x16_bf16 v[80:95], v[52:55], v[228:231], v[80:95]
  ds_read_b64_tr_b16 v[48:49], v8 offset:18432
  ds_read_b64_tr_b16 v[50:51], v8 offset:18944
  v_add_u32 v8, s34, v8
  v_rcp_f32 v32, v32
  v_fma_f32 v33, v33, v14, v14
  v_exp_f32 v34, v34
  s_lshl_b32 s32, s32, 3
  s_add_u32 s32, s32, s26
  s_lshl_b32 s32, s32, 15
  s_lshl_b32 s33, s26, 2
  s_waitcnt lgkmcnt(4)
  v_mfma_f32_32x32x16_bf16 v[80:95], v[56:59], v[232:235], v[80:95]
  ds_read_b64_tr_b16 v[52:53], v9 offset:18432
  ds_read_b64_tr_b16 v[54:55], v9 offset:18944
  v_add_u32 v9, s34, v9
  v_mul_f32 v35, v35, v79
  v_cvt_pk_bf16_f32 v37, v74, v75
  v_mul_f32 v76, v76, v32
  v_lshrrev_b32 v7, 4, v0
  v_add_u32 v7, s33, v7
  v_xor_b32 v7, v7, v0
  v_and_b32 v7, 7, v7
  s_waitcnt lgkmcnt(4)
  v_mfma_f32_32x32x16_bf16 v[80:95], v[60:63], v[236:239], v[80:95]
  ds_read_b64_tr_b16 v[56:57], v10 offset:18432
  ds_read_b64_tr_b16 v[58:59], v10 offset:18944
  v_add_u32 v10, s34, v10
  v_rcp_f32 v33, v33
  v_fma_f32 v34, v34, v14, v14
  v_exp_f32 v35, v35
  v_lshrrev_b32 v6, 3, v0
  v_lshlrev_b32 v6, 12, v6
  v_lshl_add_u32 v6, v7, 4, v6
  s_lshl_b32 s33, s26, 10
  s_waitcnt lgkmcnt(4)
  v_mfma_f32_32x32x16_bf16 v[80:95], v[48:51], v[240:243], v[80:95]
  ds_read_b64_tr_b16 v[60:61], v11 offset:18432
  ds_read_b64_tr_b16 v[62:63], v11 offset:18944
  v_add_u32 v11, s34, v11
  v_mul_f32 v77, v77, v33
  v_rcp_f32 v34, v34
  v_fma_f32 v35, v35, v14, v14
  v_mfma_f32_16x16x32_bf16 v[20:23], v[24:27], v[48:51], v[20:23]
  s_waitcnt lgkmcnt(4)
  v_mfma_f32_32x32x16_bf16 v[80:95], v[52:55], v[244:247], v[80:95]
  ds_read_b64_tr_b16 v[48:49], v8 offset:0
  ds_read_b64_tr_b16 v[50:51], v8 offset:512
  v_cvt_pk_bf16_f32 v38, v76, v77
  v_mul_f32 v78, v78, v34
  v_rcp_f32 v35, v35
  s_waitcnt lgkmcnt(4)
  v_mfma_f32_32x32x16_bf16 v[80:95], v[56:59], v[248:251], v[80:95]
  ds_write_b32 v2, v20
  v_add_u32 v2, 139264, v2
  ds_read_b64_tr_b16 v[52:53], v9 offset:0
  ds_read_b64_tr_b16 v[54:55], v9 offset:512
  v_mul_f32 v79, v79, v35
  v_cvt_pk_bf16_f32 v39, v78, v79
  buffer_store_dwordx4 v[36:39], v4, s[16:19], s43 offen sc1
  s_waitcnt lgkmcnt(5)
  v_mfma_f32_32x32x16_bf16 v[64:79], v[60:63], v[252:255], v[80:95]
  ds_read_b64_tr_b16 v[56:57], v10 offset:0
  ds_read_b64_tr_b16 v[58:59], v10 offset:512
  s_mov_b32 s43, s64
  s_mov_b32 s64, s3
  s_add_u32 s3, s3, 4096
  s_cmp_ge_u32 s71, 20
  s_mov_b32 s40, 0x358637bd
  s_cselect_b32 s40, 0xff800000, s40
  s_cselect_b32 s41, 0, 1.0
  s_cselect_b32 s42, 0, 0x358637bd
  s_add_u32 s71, s71, 1
K1_bodyL:
  s_waitcnt lgkmcnt(4)
  s_waitcnt vmcnt(1)
  s_barrier
  v_mfma_f32_32x32x16_bf16 v[80:95], v[48:51], v[96:99], 0
  ds_read_b128 v[36:39], v3
  ds_read_b64_tr_b16 v[60:61], v11 offset:0
  ds_read_b64_tr_b16 v[62:63], v11 offset:512
  v_and_b32 v28, 31, v0
  v_lshlrev_b32 v28, 3, v28
  v_lshrrev_b32 v29, 5, v0
  v_mul_u32_u24 v29, 1792, v29
  v_add_u32 v28, v28, v29
  s_mul_i32 s36, s27, 20480
  s_add_u32 s36, s36, 8192
  v_add_u32 v28, s36, v28
  ds_read_b64 v[96:97], v28 offset:0
  ds_read_b64 v[98:99], v28 offset:256
  v_mfma_f32_16x16x32_bf16 v[20:23], v[24:27], v[48:51], 0
  s_waitcnt lgkmcnt(7)
  v_mfma_f32_32x32x16_bf16 v[80:95], v[52:55], v[100:103], v[80:95]
  ds_read_b64_tr_b16 v[48:49], v8 offset:2048
  ds_read_b64_tr_b16 v[50:51], v8 offset:2560
  ds_read_b64 v[100:101], v28 offset:512
  ds_read_b64 v[102:103], v28 offset:768
  s_add_u32 m0, s33, 0
  s_nop 0
  buffer_load_dwordx4 v6, s[4:7], s32 offen offset:0 lds
  s_waitcnt lgkmcnt(9)
  v_mfma_f32_32x32x16_bf16 v[80:95], v[56:59], v[104:107], v[80:95]
  ds_read_b64_tr_b16 v[52:53], v9 offset:2048
  ds_read_b64_tr_b16 v[54:55], v9 offset:2560
  s_waitcnt lgkmcnt(10)
  v_add_f32 v36, v36, v37
  v_add_f32 v38, v38, v39
  v_add_f32 v36, v36, v38
  v_add_u32 v3, s34, v3
  s_nop 0
  v_mfma_f32_32x32x2_f32 v[64:79], v36, v19, v[64:79]
  v_add_u32 v3, 57344, v3
  s_sub_u32 s34, 0, s34
  ds_read_b64 v[104:105], v28 offset:1024
  ds_read_b64 v[106:107], v28 offset:1280
  s_waitcnt lgkmcnt(10)
  v_mfma_f32_32x32x16_bf16 v[80:95], v[60:63], v[108:111], v[80:95]
  ds_read_b64_tr_b16 v[56:57], v10 offset:2048
  ds_read_b64_tr_b16 v[58:59], v10 offset:2560
  ds_read_b64 v[108:109], v28 offset:1536
  s_waitcnt lgkmcnt(9)
  v_mfma_f32_32x32x16_bf16 v[80:95], v[48:51], v[112:115], v[80:95]
  ds_read_b64_tr_b16 v[60:61], v11 offset:2048
  ds_read_b64_tr_b16 v[62:63], v11 offset:2560
  s_add_u32 m0, s33, 16128
  s_nop 0
  buffer_load_dwordx4 v6, s[4:7], s32 offen offset:256 lds
  v_mfma_f32_16x16x32_bf16 v[20:23], v[24:27], v[48:51], v[20:23]
  s_waitcnt lgkmcnt(7)
  v_mfma_f32_32x32x16_bf16 v[80:95], v[52:55], v[116:119], v[80:95]
  ds_read_b64_tr_b16 v[48:49], v8 offset:4096
  ds_read_b64_tr_b16 v[50:51], v8 offset:4608
  s_waitcnt lgkmcnt(4)
  v_and_b32 v30, v97, v99
  v_and_b32 v31, v101, v103
  v_and_b32 v32, v105, v107
  v_and_b32 v30, v30, v109
  v_and_b32 v31, v31, v32
  v_and_b32 v30, v30, v31
  v_cmp_gt_i32 vcc, 0, v30
  s_nop 0
  s_cmp_eq_u64 vcc, -1
  s_cselect_b32 s36, 1, 0
  v_mov_b32 v30, s36
  v_mov_b32 v31, 11776
  s_mov_b64 exec, 1
  ds_add_u32 v31, v30
  s_mov_b64 exec, -1
  v_mfma_f32_32x32x16_bf16 v[80:95], v[56:59], v[120:123], v[80:95]
  ds_read_b64_tr_b16 v[52:53], v9 offset:4096
  ds_read_b64_tr_b16 v[54:55], v9 offset:4608
  v_add_f32 v96, v96, v104
  v_add_f32 v97, v97, v105
  v_add_f32 v98, v98, v106
  v_add_f32 v99, v99, v107
  v_add_f32 v100, v100, v108
  v_add_f32 v101, v101, v109
  s_waitcnt lgkmcnt(5)
  v_mfma_f32_32x32x16_bf16 v[80:95], v[60:63], v[124:127], v[80:95]
  ds_read_b64_tr_b16 v[56:57], v10 offset:4096
  ds_read_b64_tr_b16 v[58:59], v10 offset:4608
  v_add_f32 v96, v96, v102
  v_add_f32 v97, v97, v103
  v_add_f32 v98, v98, v100
  v_add_f32 v99, v99, v101
  v_add_f32 v96, v96, v98
  v_add_f32 v97, v97, v99
  s_add_u32 m0, s33, 32256
  s_nop 0
  buffer_load_dwordx4 v6, s[4:7], s32 offen offset:512 lds
  s_waitcnt lgkmcnt(4)
  s_barrier
  v_mfma_f32_32x32x16_bf16 v[80:95], v[48:51], v[128:131], v[80:95]
  ds_read_b64_tr_b16 v[60:61], v11 offset:4096
  ds_read_b64_tr_b16 v[62:63], v11 offset:4608
  ds_read_b32 v30, v31
  v_mov_b32 v98, v96
  v_mov_b32 v99, v97
  v_lshlrev_b32 v120, 16, v40
  v_and_b32 v121, 0xffff0000, v40
  v_permlane32_swap_b32 v96, v98
  v_permlane32_swap_b32 v97, v99
  v_add_f32 v96, v96, v98
  v_add_f32 v97, v97, v99
  v_mul_f32 v96, 0xba97b426, v96
  v_mfma_f32_16x16x32_bf16 v[20:23], v[24:27], v[48:51], v[20:23]
  s_waitcnt lgkmcnt(5)
  v_mfma_f32_32x32x16_bf16 v[80:95], v[52:55], v[132:135], v[80:95]
  ds_read_b64_tr_b16 v[48:49], v8 offset:6144
  ds_read_b64_tr_b16 v[50:51], v8 offset:6656
  v_mul_f32 v97, 0xba97b426, v97
  v_fma_f32 v97, -v96, v96, v97
  v_max_f32 v97, 0, v97
  v_add_f32 v97, 0x3727c5ac, v97
  v_rsq_f32 v97, v97
  v_lshlrev_b32 v122, 16, v41
  v_and_b32 v123, 0xffff0000, v41
  v_add_f32 v120, v120, v96
  v_add_f32 v121, v121, v96
  s_waitcnt lgkmcnt(5)
  v_mfma_f32_32x32x16_bf16 v[80:95], v[56:59], v[136:139], v[80:95]
  ds_read_b64_tr_b16 v[52:53], v9 offset:6144
  ds_read_b64_tr_b16 v[54:55], v9 offset:6656
  v_lshlrev_b32 v124, 16, v42
  v_and_b32 v125, 0xffff0000, v42
  v_mul_f32 v120, v120, v97
  v_mul_f32 v121, v121, v97
  v_cvt_pk_bf16_f32 v112, v120, v121
  v_add_f32 v122, v122, v96
  v_add_f32 v123, v123, v96
  v_lshlrev_b32 v126, 16, v43
  v_and_b32 v127, 0xffff0000, v43
  s_waitcnt lgkmcnt(5)
  v_mfma_f32_32x32x16_bf16 v[80:95], v[60:63], v[140:143], v[80:95]
  ds_read_b64_tr_b16 v[56:57], v10 offset:6144
  ds_read_b64_tr_b16 v[58:59], v10 offset:6656
  v_mul_f32 v122, v122, v97
  v_mul_f32 v123, v123, v97
  v_cvt_pk_bf16_f32 v113, v122, v123
  v_add_f32 v124, v124, v96
  v_add_f32 v125, v125, v96
  v_lshlrev_b32 v120, 16, v44
  v_and_b32 v121, 0xffff0000, v44
  v_mul_f32 v124, v124, v97
  v_mul_f32 v125, v125, v97
  s_waitcnt lgkmcnt(4)
  v_mfma_f32_32x32x16_bf16 v[80:95], v[48:51], v[144:147], v[80:95]
  ds_read_b64_tr_b16 v[60:61], v11 offset:6144
  ds_read_b64_tr_b16 v[62:63], v11 offset:6656
  v_readfirstlane_b32 s67, v30
  s_nop 0
  s_cmp_eq_u32 s67, 8
  s_cselect_b32 s38, 1, 0
  s_cselect_b32 s36, s69, 0x40000000
  s_cselect_b32 s65, s65, 99
  v_cvt_pk_bf16_f32 v114, v124, v125
  v_add_f32 v126, v126, v96
  v_add_f32 v127, v127, v96
  v_lshlrev_b32 v122, 16, v45
  v_and_b32 v123, 0xffff0000, v45
  v_mul_f32 v126, v126, v97
  v_mul_f32 v127, v127, v97
  v_cvt_pk_bf16_f32 v115, v126, v127
  v_mfma_f32_16x16x32_bf16 v[20:23], v[24:27], v[48:51], v[20:23]
  s_waitcnt lgkmcnt(4)
  v_mfma_f32_32x32x16_bf16 v[80:95], v[52:55], v[148:151], v[80:95]
  ds_read_b64_tr_b16 v[48:49], v8 offset:8192
  ds_read_b64_tr_b16 v[50:51], v8 offset:8704
  v_add_f32 v120, v120, v96
  v_add_f32 v121, v121, v96
  v_lshlrev_b32 v124, 16, v46
  v_and_b32 v125, 0xffff0000, v46
  v_mul_f32 v120, v120, v97
  v_mul_f32 v121, v121, v97
  v_cvt_pk_bf16_f32 v116, v120, v121
  v_add_f32 v122, v122, v96
  s_waitcnt lgkmcnt(4)
  v_mfma_f32_32x32x16_bf16 v[80:95], v[56:59], v[152:155], v[80:95]
  ds_read_b64_tr_b16 v[52:53], v9 offset:8192
  ds_read_b64_tr_b16 v[54:55], v9 offset:8704
  v_add_f32 v123, v123, v96
  v_lshlrev_b32 v126, 16, v47
  v_and_b32 v127, 0xffff0000, v47
  v_mul_f32 v122, v122, v97
  v_mul_f32 v123, v123, v97
  v_cvt_pk_bf16_f32 v117, v122, v123
  v_add_f32 v124, v124, v96
  v_add_f32 v125, v125, v96
  s_waitcnt lgkmcnt(4)
  v_mfma_f32_32x32x16_bf16 v[80:95], v[60:63], v[156:159], v[80:95]
  ds_read_b64_tr_b16 v[56:57], v10 offset:8192
  ds_read_b64_tr_b16 v[58:59], v10 offset:8704
  v_mul_f32 v124, v124, v97
  v_mul_f32 v125, v125, v97
  v_cvt_pk_bf16_f32 v118, v124, v125
  v_add_f32 v126, v126, v96
  v_add_f32 v127, v127, v96
  v_mul_f32 v126, v126, v97
  v_mul_f32 v127, v127, v97
  v_cvt_pk_bf16_f32 v119, v126, v127
  buffer_store_dwordx4 v[112:115], v5, s[16:19], s36 offen sc1
  buffer_store_dwordx4 v[116:119], v4, s[16:19], s36 offen sc1
  s_barrier
  s_waitcnt lgkmcnt(4)
  v_mfma_f32_32x32x16_bf16 v[80:95], v[48:51], v[160:163], v[80:95]
  ds_read_b64_tr_b16 v[60:61], v11 offset:8192
  ds_read_b64_tr_b16 v[62:63], v11 offset:8704
  v_mul_f32 v28, v64, v17
  v_exp_f32 v28, v28 clamp
  v_mul_f32 v29, v65, v17
  v_fma_f32 v64, v64, v18, s42
  s_add_u32 m0, s33, 8064
  s_nop 0
  buffer_load_dwordx4 v6, s[4:7], s32 offen offset:128 lds
  v_mfma_f32_16x16x32_bf16 v[20:23], v[24:27], v[48:51], v[20:23]
  s_waitcnt lgkmcnt(4)
  v_mfma_f32_32x32x16_bf16 v[80:95], v[52:55], v[164:167], v[80:95]
  ds_read_b64_tr_b16 v[144:145], v8 offset:16384
  ds_read_b64_tr_b16 v[146:147], v8 offset:16896
  ds_read_b64_tr_b16 v[48:49], v8 offset:10240
  ds_read_b64_tr_b16 v[50:51], v8 offset:10752
  v_exp_f32 v29, v29 clamp
  v_mul_f32 v30, v66, v17
  v_max_f32 v64, s40, v64
  v_fma_f32 v65, v65, v18, s42
  s_waitcnt lgkmcnt(6)
  v_mfma_f32_32x32x16_bf16 v[80:95], v[56:59], v[168:171], v[80:95]
  ds_read_b64_tr_b16 v[148:149], v8 offset:18432
  ds_read_b64_tr_b16 v[150:151], v8 offset:18944
  ds_read_b64_tr_b16 v[52:53], v9 offset:10240
  ds_read_b64_tr_b16 v[54:55], v9 offset:10752
  v_exp_f32 v30, v30 clamp
  v_mul_f32 v31, v67, v17
  v_fma_f32 v64, v28, s41, v64
  v_max_f32 v65, s40, v65
  s_add_u32 m0, s33, 24192
  s_nop 0
  buffer_load_dwordx4 v6, s[4:7], s32 offen offset:384 lds
  s_waitcnt lgkmcnt(8)
  v_mfma_f32_32x32x16_bf16 v[80:95], v[60:63], v[172:175], v[80:95]
  ds_read_b64_tr_b16 v[56:57], v10 offset:10240
  ds_read_b64_tr_b16 v[58:59], v10 offset:10752
  v_fma_f32 v66, v66, v18, s42
  v_exp_f32 v31, v31 clamp
  v_mul_f32 v32, v68, v17
  v_fma_f32 v65, v29, s41, v65
  s_waitcnt lgkmcnt(6)
  v_mfma_f32_32x32x16_bf16 v[80:95], v[48:51], v[176:179], v[80:95]
  ds_read_b64_tr_b16 v[60:61], v11 offset:10240
  ds_read_b64_tr_b16 v[62:63], v11 offset:10752
  v_max_f32 v66, s40, v66
  v_fma_f32 v67, v67, v18, s42
  v_exp_f32 v32, v32 clamp
  v_mul_f32 v33, v69, v17
  s_add_u32 m0, s33, 40320
  s_nop 0
  buffer_load_dwordx4 v6, s[4:7], s32 offen offset:640 lds
  v_mfma_f32_16x16x32_bf16 v[20:23], v[24:27], v[48:51], v[20:23]
  s_waitcnt lgkmcnt(4)
  v_mfma_f32_32x32x16_bf16 v[80:95], v[52:55], v[180:183], v[80:95]
  ds_read_b64_tr_b16 v[48:49], v8 offset:12288
  ds_read_b64_tr_b16 v[50:51], v8 offset:12800
  v_cvt_pk_bf16_f32 v36, v64, v65
  v_fma_f32 v66, v30, s41, v66
  v_max_f32 v67, s40, v67
  v_fma_f32 v68, v68, v18, s42
  s_waitcnt lgkmcnt(4)
  v_mfma_f32_32x32x16_bf16 v[80:95], v[56:59], v[184:187], v[80:95]
  ds_read_b64_tr_b16 v[52:53], v9 offset:12288
  ds_read_b64_tr_b16 v[54:55], v9 offset:12800
  v_exp_f32 v33, v33 clamp
  v_mul_f32 v34, v70, v17
  v_fma_f32 v67, v31, s41, v67
  v_max_f32 v68, s40, v68
  v_mfma_f32_16x16x32_bf16 v[20:23], v[24:27], v[144:147], v[20:23]
  s_waitcnt lgkmcnt(4)
  v_mfma_f32_32x32x16_bf16 v[80:95], v[60:63], v[188:191], v[80:95]
  ds_read_b64_tr_b16 v[56:57], v10 offset:12288
  ds_read_b64_tr_b16 v[58:59], v10 offset:12800
  v_fma_f32 v69, v69, v18, s42
  v_exp_f32 v34, v34 clamp
  v_mul_f32 v35, v71, v17
  s_barrier
  s_waitcnt lgkmcnt(4)
  v_mfma_f32_32x32x16_bf16 v[80:95], v[48:51], v[192:195], v[80:95]
  ds_read_b64_tr_b16 v[60:61], v11 offset:12288
  ds_read_b64_tr_b16 v[62:63], v11 offset:12800
  v_cvt_pk_bf16_f32 v37, v66, v67
  v_fma_f32 v68, v32, s41, v68
  v_max_f32 v69, s40, v69
  v_fma_f32 v70, v70, v18, s42
  v_mfma_f32_16x16x32_bf16 v[20:23], v[24:27], v[48:51], v[20:23]
  s_waitcnt lgkmcnt(4)
  v_mfma_f32_32x32x16_bf16 v[80:95], v[52:55], v[196:199], v[80:95]
  ds_read_b64_tr_b16 v[48:49], v8 offset:14336
  ds_read_b64_tr_b16 v[50:51], v8 offset:14848
  v_exp_f32 v35, v35 clamp
  v_mul_f32 v28, v72, v17
  buffer_store_dwordx2 v[36:37], v1, s[16:19], s43 offen offset:0 sc1
  v_fma_f32 v69, v33, s41, v69
  s_waitcnt lgkmcnt(4)
  v_mfma_f32_32x32x16_bf16 v[80:95], v[56:59], v[200:203], v[80:95]
  ds_read_b64_tr_b16 v[52:53], v9 offset:14336
  ds_read_b64_tr_b16 v[54:55], v9 offset:14848
  v_max_f32 v70, s40, v70
  v_fma_f32 v71, v71, v18, s42
  v_exp_f32 v28, v28 clamp
  v_mul_f32 v29, v73, v17
  v_mfma_f32_16x16x32_bf16 v[20:23], v[24:27], v[148:151], v[20:23]
  s_waitcnt lgkmcnt(4)
  v_mfma_f32_32x32x16_bf16 v[80:95], v[60:63], v[204:207], v[80:95]
  ds_read_b64_tr_b16 v[56:57], v10 offset:14336
  ds_read_b64_tr_b16 v[58:59], v10 offset:14848
  v_cvt_pk_bf16_f32 v38, v68, v69
  v_fma_f32 v70, v34, s41, v70
  v_max_f32 v71, s40, v71
  v_fma_f32 v72, v72, v18, s42
  s_waitcnt lgkmcnt(4)
  v_mfma_f32_32x32x16_bf16 v[80:95], v[48:51], v[208:211], v[80:95]
  ds_read_b64_tr_b16 v[60:61], v11 offset:14336
  ds_read_b64_tr_b16 v[62:63], v11 offset:14848
  v_exp_f32 v29, v29 clamp
  v_mul_f32 v30, v74, v17
  v_fma_f32 v71, v35, s41, v71
  v_max_f32 v72, s40, v72
  v_mfma_f32_16x16x32_bf16 v[20:23], v[24:27], v[48:51], v[20:23]
  s_waitcnt lgkmcnt(4)
  v_mfma_f32_32x32x16_bf16 v[80:95], v[52:55], v[212:215], v[80:95]
  ds_read_b64_tr_b16 v[48:49], v8 offset:16384
  ds_read_b64_tr_b16 v[50:51], v8 offset:16896
  v_fma_f32 v73, v73, v18, s42
  v_exp_f32 v30, v30 clamp
  v_mul_f32 v31, v75, v17
  v_cvt_pk_bf16_f32 v39, v70, v71
  s_waitcnt lgkmcnt(4)
  v_mfma_f32_32x32x16_bf16 v[80:95], v[56:59], v[216:219], v[80:95]
  ds_write_b32 v2, v20
  ds_read_b64_tr_b16 v[52:53], v9 offset:16384
  ds_read_b64_tr_b16 v[54:55], v9 offset:16896
  v_fma_f32 v72, v28, s41, v72
  v_max_f32 v73, s40, v73
  v_fma_f32 v74, v74, v18, s42
  v_exp_f32 v31, v31 clamp
  s_waitcnt lgkmcnt(5)
  v_mfma_f32_32x32x16_bf16 v[80:95], v[60:63], v[220:223], v[80:95]
  ds_read_b64_tr_b16 v[56:57], v10 offset:16384
  ds_read_b64_tr_b16 v[58:59], v10 offset:16896
  v_mul_f32 v32, v76, v17
  buffer_store_dwordx2 v[38:39], v1, s[16:19], s43 offen offset:512 sc1
  v_fma_f32 v73, v29, s41, v73
  s_waitcnt lgkmcnt(4)
  s_waitcnt vmcnt(5)
  s_barrier
  v_mfma_f32_32x32x16_bf16 v[80:95], v[48:51], v[224:227], v[80:95]
  ds_read_b128 v[152:155], v3
  ds_read_b64_tr_b16 v[60:61], v11 offset:16384
  ds_read_b64_tr_b16 v[62:63], v11 offset:16896
  v_max_f32 v74, s40, v74
  v_fma_f32 v75, v75, v18, s42
  v_exp_f32 v32, v32 clamp
  v_mul_f32 v33, v77, v17
  v_cvt_pk_bf16_f32 v36, v72, v73
  s_cmp_eq_u32 s38, 0
  s_cbranch_scc1 Lrare_6
Lback_7:
  s_waitcnt lgkmcnt(5)
  v_mfma_f32_32x32x16_bf16 v[80:95], v[52:55], v[228:231], v[80:95]
  ds_read_b64_tr_b16 v[48:49], v8 offset:18432
  ds_read_b64_tr_b16 v[50:51], v8 offset:18944
  v_fma_f32 v74, v30, s41, v74
  v_max_f32 v75, s40, v75
  v_fma_f32 v76, v76, v18, s42
  v_exp_f32 v33, v33 clamp
  v_mul_f32 v34, v78, v17
  s_cmp_lg_u32 s65, 2
  s_cbranch_scc1 Lns_8
  v_mov_b32 v12, 1
  v_lshlrev_b32 v13, 7, v0
  s_mov_b64 exec, 0xff
  buffer_atomic_add v12, v13, s[16:19], s68 offen sc1
  s_mov_b64 exec, -1
Lns_8:
  s_waitcnt lgkmcnt(5)
  v_mfma_f32_32x32x16_bf16 v[80:95], v[56:59], v[232:235], v[80:95]
  s_load_dwordx4 s[48:51], s[0:1], 40
  s_load_dwordx2 s[52:53], s[0:1], 80
  s_load_dwordx2 s[54:55], s[0:1], 0
  s_load_dwordx2 s[62:63], s[0:1], 64
  ds_read_b64_tr_b16 v[52:53], v9 offset:18432
  ds_read_b64_tr_b16 v[54:55], v9 offset:18944
  v_fma_f32 v75, v31, s41, v75
  v_max_f32 v76, s40, v76
  v_fma_f32 v77, v77, v18, s42
  v_exp_f32 v34, v34 clamp
  s_waitcnt lgkmcnt(4)
  v_mfma_f32_32x32x16_bf16 v[80:95], v[60:63], v[236:239], v[80:95]
  ds_read_b64_tr_b16 v[56:57], v10 offset:18432
  ds_read_b64_tr_b16 v[58:59], v10 offset:18944
  v_mul_f32 v35, v79, v17
  v_cvt_pk_bf16_f32 v37, v74, v75
  v_fma_f32 v76, v32, s41, v76
  v_max_f32 v77, s40, v77
  v_add_f32 v152, v152, v153
  v_add_f32 v154, v154, v155
  v_add_f32 v152, v152, v154
  s_nop 1
  v_mfma_f32_32x32x2_f32 v[80:95], v152, v19, v[80:95]
  s_waitcnt lgkmcnt(4)
  v_mfma_f32_32x32x16_bf16 v[80:95], v[48:51], v[240:243], v[80:95]
  ds_read_b64_tr_b16 v[60:61], v11 offset:18432
  ds_read_b64_tr_b16 v[62:63], v11 offset:18944
  v_fma_f32 v78, v78, v18, s42
  v_exp_f32 v35, v35 clamp
  buffer_store_dwordx2 v[36:37], v1, s[16:19], s43 offen offset:1024 sc1
  v_fma_f32 v77, v33, s41, v77
  s_waitcnt lgkmcnt(4)
  v_mfma_f32_32x32x16_bf16 v[80:95], v[52:55], v[244:247], v[80:95]
  v_max_f32 v78, s40, v78
  v_fma_f32 v79, v79, v18, s42
  v_cvt_pk_bf16_f32 v38, v76, v77
  v_fma_f32 v78, v34, s41, v78
  s_waitcnt lgkmcnt(2)
  v_mfma_f32_32x32x16_bf16 v[80:95], v[56:59], v[248:251], v[80:95]
  v_max_f32 v79, s40, v79
  v_fma_f32 v79, v35, s41, v79
  v_cvt_pk_bf16_f32 v39, v78, v79
  buffer_store_dwordx2 v[38:39], v1, s[16:19], s43 offen offset:1536 sc1
  s_waitcnt lgkmcnt(0)
  v_mfma_f32_32x32x16_bf16 v[64:79], v[60:63], v[252:255], v[80:95]
  s_mov_b32 s43, s64
  s_mov_b32 s64, s3
  s_add_u32 s3, s3, 4096
  s_cmp_ge_u32 s71, 20
  s_mov_b32 s40, 0x358637bd
  s_cselect_b32 s40, 0xff800000, s40
  s_cselect_b32 s41, 0, 1.0
  s_cselect_b32 s42, 0, 0x358637bd
  s_add_u32 s71, s71, 1
  s_waitcnt lgkmcnt(0)
  s_cmp_eq_u32 s38, 0
  s_cbranch_scc1 Lrare_9
Lback_10:
  s_add_u32 s71, s68, 1024
  s_mov_b32 s70, s56
  s_mov_b32 s69, s38
  v_and_b32 v21, 15, v0
  v_lshlrev_b32 v21, 11, v21
  v_lshlrev_b32 v10, 4, v0
  s_bfe_u32 s24, s2, 0x20001
  s_lshl_b32 s24, s24, 3
  s_lshr_b32 s36, s2, 5
  s_add_u32 s24, s24, s36
  s_and_b32 s25, s2, 1
  s_lshl_b32 s25, s25, 2
  s_bfe_u32 s36, s2, 0x20003
  s_add_u32 s25, s25, s36
  s_and_b32 s27, s26, 1
  s_bfe_u32 s28, s26, 0x10001
  s_cmp_ge_u32 s26, 4
  s_cbranch_scc1 Learly_11
  s_cmp_lg_u32 s70, 16
  s_cbranch_scc1 Lrare_12
Lback_13:
  s_and_b32 s39, s2, 7
  s_lshl_b32 s39, s39, 7
  s_add_u32 s39, s39, 0x16a0000
  v_lshrrev_b32 v11, 3, v0
  s_lshl_b32 s37, s26, 4
  v_add_u32 v11, s37, v11
  v_lshlrev_b32 v11, 12, v11
  v_lshrrev_b32 v6, 4, v0
  v_and_b32 v7, 7, v0
  v_xor_b32 v6, v6, v7
  v_lshl_add_u32 v8, v6, 4, v11
  v_xor_b32 v6, 4, v6
  v_lshl_add_u32 v9, v6, 4, v11
  v_add_u32 v9, 31744, v9
  s_lshl_b32 s29, s24, 18
  s_lshl_b32 s35, s26, 11
  s_mov_b32 s4, s48
  s_and_b32 s5, s49, 0xffff
  s_mov_b32 s6, 0x800000
  s_mov_b32 s7, 0x20000
  s_add_u32 s29, s29, 768
  s_mul_i32 s67, s28, 7
  s_lshl_b32 s37, s27, 2
  s_add_u32 s67, s67, s37
  s_lshl_b32 s67, s67, 10
  s_mul_i32 s30, s28, 108
  s_add_u32 s30, s30, s37
  s_mul_i32 s37, s25, 7
  s_add_u32 s30, s30, s37
  s_lshl_b32 s30, s30, 10
  s_add_u32 s30, s30, 7919616
  s_mov_b32 s46, s27
  s_mov_b32 s47, 0
  s_mov_b64 vcc, s[46:47]
Learly_11:
  v_mul_f32 v28, v64, v17
  v_exp_f32 v28, v28 clamp
  v_mul_f32 v29, v65, v17
  v_fma_f32 v64, v64, v18, s42
  v_exp_f32 v29, v29 clamp
  v_mul_f32 v30, v66, v17
  v_max_f32 v64, s40, v64
  v_fma_f32 v65, v65, v18, s42
  v_exp_f32 v30, v30 clamp
  v_mul_f32 v31, v67, v17
  v_fma_f32 v64, v28, s41, v64
  v_max_f32 v65, s40, v65
  v_fma_f32 v66, v66, v18, s42
  v_exp_f32 v31, v31 clamp
  v_mul_f32 v32, v68, v17
  v_fma_f32 v65, v29, s41, v65
  v_max_f32 v66, s40, v66
  v_fma_f32 v67, v67, v18, s42
  v_exp_f32 v32, v32 clamp
  v_mul_f32 v33, v69, v17
  v_cvt_pk_bf16_f32 v36, v64, v65
  v_fma_f32 v66, v30, s41, v66
  v_max_f32 v67, s40, v67
  v_fma_f32 v68, v68, v18, s42
  v_exp_f32 v33, v33 clamp
  v_mul_f32 v34, v70, v17
  v_fma_f32 v67, v31, s41, v67
  v_max_f32 v68, s40, v68
  v_fma_f32 v69, v69, v18, s42
  v_exp_f32 v34, v34 clamp
  v_mul_f32 v35, v71, v17
  v_cvt_pk_bf16_f32 v37, v66, v67
  v_fma_f32 v68, v32, s41, v68
  v_max_f32 v69, s40, v69
  v_fma_f32 v70, v70, v18, s42
  v_exp_f32 v35, v35 clamp
  v_mul_f32 v28, v72, v17
  s_cmp_lg_u32 s26, 0
  s_cbranch_scc1 Lnp_14
  buffer_load_dword v20, v21, s[16:19], s39 offen sc1
Lnp_14:
  buffer_store_dwordx2 v[36:37], v1, s[16:19], s43 offen offset:0 sc1
  v_fma_f32 v69, v33, s41, v69
  v_max_f32 v70, s40, v70
  v_fma_f32 v71, v71, v18, s42
  v_exp_f32 v28, v28 clamp
  v_mul_f32 v29, v73, v17
  v_cvt_pk_bf16_f32 v38, v68, v69
  v_fma_f32 v70, v34, s41, v70
  v_max_f32 v71, s40, v71
  v_fma_f32 v72, v72, v18, s42
  v_exp_f32 v29, v29 clamp
  v_mul_f32 v30, v74, v17
  v_fma_f32 v71, v35, s41, v71
  v_max_f32 v72, s40, v72
  v_fma_f32 v73, v73, v18, s42
  v_exp_f32 v30, v30 clamp
  v_mul_f32 v31, v75, v17
  v_cvt_pk_bf16_f32 v39, v70, v71
  v_fma_f32 v72, v28, s41, v72
  v_max_f32 v73, s40, v73
  v_fma_f32 v74, v74, v18, s42
  v_exp_f32 v31, v31 clamp
  v_mul_f32 v32, v76, v17
  buffer_store_dwordx2 v[38:39], v1, s[16:19], s43 offen offset:512 sc1
  v_fma_f32 v73, v29, s41, v73
  v_max_f32 v74, s40, v74
  v_fma_f32 v75, v75, v18, s42
  v_exp_f32 v32, v32 clamp
  v_mul_f32 v33, v77, v17
  v_cvt_pk_bf16_f32 v36, v72, v73
  v_fma_f32 v74, v30, s41, v74
  v_max_f32 v75, s40, v75
  v_fma_f32 v76, v76, v18, s42
  v_exp_f32 v33, v33 clamp
  v_mul_f32 v34, v78, v17
  v_fma_f32 v75, v31, s41, v75
  v_max_f32 v76, s40, v76
  v_fma_f32 v77, v77, v18, s42
  v_exp_f32 v34, v34 clamp
  v_mul_f32 v35, v79, v17
  v_cvt_pk_bf16_f32 v37, v74, v75
  v_fma_f32 v76, v32, s41, v76
  v_max_f32 v77, s40, v77
  v_fma_f32 v78, v78, v18, s42
  v_exp_f32 v35, v35 clamp
  buffer_store_dwordx2 v[36:37], v1, s[16:19], s43 offen offset:1024 sc1
  v_fma_f32 v77, v33, s41, v77
  v_max_f32 v78, s40, v78
  v_fma_f32 v79, v79, v18, s42
  v_cvt_pk_bf16_f32 v38, v76, v77
  v_fma_f32 v78, v34, s41, v78
  v_max_f32 v79, s40, v79
  v_fma_f32 v79, v35, s41, v79
  v_cvt_pk_bf16_f32 v39, v78, v79
  buffer_store_dwordx2 v[38:39], v1, s[16:19], s43 offen offset:1536 sc1
P2_entry:
  s_cmp_ge_u32 s26, 4
  s_cbranch_scc1 K2_consumer
K2_loader:
  v_mov_b32 v6, 155648
  s_cmp_lg_u32 s26, 0
  s_cbranch_scc1 K2_nw0
  s_waitcnt vmcnt(4)
  v_cmp_eq_u32 s[46:47], 14, v20
  s_nop 0
  s_cmp_eq_u64 s[46:47], -1
  s_cselect_b32 s36, 1, 0
  v_mov_b32 v7, s36
  ds_write_b32 v6, v7
  s_waitcnt lgkmcnt(0)
K2_nw0:
  s_barrier
  ds_read_b32 v7, v6
  s_waitcnt lgkmcnt(0)
  v_readfirstlane_b32 s36, v7
  s_nop 0
  s_cmp_eq_u32 s36, 1
  s_cbranch_scc0 Lrare_15
  s_add_u32 m0, s67, 124928
  s_nop 0
  buffer_load_dwordx4 v10, s[16:19], s30 offen offset:0 sc1 lds
  buffer_load_dwordx4 v10, s[16:19], s30 offen offset:1024 sc1 lds
  buffer_load_dwordx4 v10, s[16:19], s30 offen offset:2048 sc1 lds
  s_cbranch_vccnz Lsk_17
  buffer_load_dwordx4 v10, s[16:19], s30 offen offset:3072 sc1 lds
Lsk_17:
  s_add_u32 s30, s30, 221184
  s_add_u32 m0, s67, 139264
  s_nop 0
  buffer_load_dwordx4 v10, s[16:19], s30 offen offset:0 sc1 lds
  buffer_load_dwordx4 v10, s[16:19], s30 offen offset:1024 sc1 lds
  buffer_load_dwordx4 v10, s[16:19], s30 offen offset:2048 sc1 lds
  s_cbranch_vccnz Lsk_18
  buffer_load_dwordx4 v10, s[16:19], s30 offen offset:3072 sc1 lds
Lsk_18:
  s_add_u32 s30, s30, 221184
  s_add_u32 m0, s67, 81920
  s_nop 0
  buffer_load_dwordx4 v10, s[16:19], s30 offen offset:0 sc1 lds
  buffer_load_dwordx4 v10, s[16:19], s30 offen offset:1024 sc1 lds
  buffer_load_dwordx4 v10, s[16:19], s30 offen offset:2048 sc1 lds
  s_cbranch_vccnz Lsk_19
  buffer_load_dwordx4 v10, s[16:19], s30 offen offset:3072 sc1 lds
Lsk_19:
  s_add_u32 s30, s30, 221184
  s_waitcnt vmcnt(9)
  s_barrier
  s_barrier
Lback_16:
  v_and_b32 v21, 1, v0
  v_lshlrev_b32 v21, 11, v21
  s_lshr_b32 s39, s24, 2
  s_lshl_b32 s39, s39, 12
  s_add_u32 s39, s39, 0x16a0400
  s_lshl_b32 s36, s25, 7
  s_add_u32 s39, s39, s36
  s_add_u32 m0, s67, 96256
  s_nop 0
  buffer_load_dwordx4 v10, s[16:19], s30 offen offset:0 sc1 lds
  buffer_load_dwordx4 v10, s[16:19], s30 offen offset:1024 sc1 lds
  buffer_load_dwordx4 v10, s[16:19], s30 offen offset:2048 sc1 lds
  s_cbranch_vccnz Lsk_20
  buffer_load_dwordx4 v10, s[16:19], s30 offen offset:3072 sc1 lds
Lsk_20:
  s_add_u32 s30, s30, 221184
  s_add_u32 m0, s67, 110592
  s_nop 0
  buffer_load_dwordx4 v10, s[16:19], s30 offen offset:0 sc1 lds
  buffer_load_dwordx4 v10, s[16:19], s30 offen offset:1024 sc1 lds
  buffer_load_dwordx4 v10, s[16:19], s30 offen offset:2048 sc1 lds
  s_cbranch_vccnz Lsk_21
  buffer_load_dwordx4 v10, s[16:19], s30 offen offset:3072 sc1 lds
Lsk_21:
  s_add_u32 s30, s30, 221184
  s_waitcnt vmcnt(12)
  s_barrier
  s_waitcnt vmcnt(9)
  s_barrier
  s_add_u32 m0, s67, 124928
  s_nop 0
  buffer_load_dwordx4 v10, s[16:19], s30 offen offset:0 sc1 lds
  buffer_load_dwordx4 v10, s[16:19], s30 offen offset:1024 sc1 lds
  buffer_load_dwordx4 v10, s[16:19], s30 offen offset:2048 sc1 lds
  s_cbranch_vccnz Lsk_22
  buffer_load_dwordx4 v10, s[16:19], s30 offen offset:3072 sc1 lds
Lsk_22:
  s_add_u32 s30, s30, 221184
  s_add_u32 m0, s35, 49152
  s_nop 0
  buffer_load_dwordx4 v8, s[4:7], s29 offen lds
  buffer_load_dwordx4 v9, s[4:7], s29 offen offset:1024 lds
  s_add_u32 s29, s29, 128
  s_waitcnt vmcnt(11)
  s_barrier
  buffer_load_dword v20, v21, s[16:19], s39 offen sc1
  s_add_u32 m0, s67, 139264
  s_nop 0
  buffer_load_dwordx4 v10, s[16:19], s30 offen offset:0 sc1 lds
  buffer_load_dwordx4 v10, s[16:19], s30 offen offset:1024 sc1 lds
  buffer_load_dwordx4 v10, s[16:19], s30 offen offset:2048 sc1 lds
  s_cbranch_vccnz Lsk_23
  buffer_load_dwordx4 v10, s[16:19], s30 offen offset:3072 sc1 lds
Lsk_23:
  s_add_u32 s30, s30, 221184
  s_add_u32 m0, s35, 57344
  s_nop 0
  buffer_load_dwordx4 v8, s[4:7], s29 offen lds
  buffer_load_dwordx4 v9, s[4:7], s29 offen offset:1024 lds
  s_add_u32 s29, s29, 128
  s_waitcnt vmcnt(14)
  s_barrier
  s_add_u32 m0, s67, 81920
  s_nop 0
  buffer_load_dwordx4 v10, s[16:19], s30 offen offset:0 sc1 lds
  buffer_load_dwordx4 v10, s[16:19], s30 offen offset:1024 sc1 lds
  buffer_load_dwordx4 v10, s[16:19], s30 offen offset:2048 sc1 lds
  s_cbranch_vccnz Lsk_24
  buffer_load_dwordx4 v10, s[16:19], s30 offen offset:3072 sc1 lds
Lsk_24:
  s_add_u32 s30, s30, 221184
  s_add_u32 m0, s35, 65536
  s_nop 0
  buffer_load_dwordx4 v8, s[4:7], s29 offen lds
  buffer_load_dwordx4 v9, s[4:7], s29 offen offset:1024 lds
  s_add_u32 s29, s29, 128
  s_waitcnt vmcnt(16)
  s_barrier
  s_waitcnt vmcnt(10)
Lchk_25:
  v_cmp_eq_u32 s[46:47], 16, v20
  s_nop 0
  s_cmp_eq_u64 s[46:47], -1
  s_cbranch_scc1 Lok_26
  s_sleep 3
  buffer_load_dword v20, v21, s[16:19], s39 offen sc1
  s_waitcnt vmcnt(0)
  s_branch Lchk_25
Lok_26:
  s_and_b32 s64, s24, 3
  s_andn2_b32 s36, s24, 3
  s_add_u32 s36, s36, s26
  s_mul_i32 s36, s36, 240
  s_lshl_b32 s36, s36, 10
  s_lshl_b32 s37, s25, 2
  s_add_u32 s37, s37, s64
  s_mul_i32 s37, s37, 1280
  s_add_u32 s36, s36, s37
  s_add_u32 s31, s36, 40960
  s_lshl_b32 s32, s26, 13
  v_bfe_u32 v6, v0, 4, 1
  v_mul_u32_u24 v6, 122880, v6
  v_lshrrev_b32 v7, 5, v0
  v_mul_u32_u24 v7, 40960, v7
  v_add_u32 v6, v6, v7
  v_and_b32 v7, 15, v0
  v_lshl_add_u32 v18, v7, 4, v6
  s_add_u32 m0, s32, 0
  s_add_u32 s37, s31, 0
  buffer_load_dwordx4 v10, s[16:19], s37 offen sc1 lds
  s_add_u32 m0, s32, 1024
  s_add_u32 s37, s31, 122880
  buffer_load_dwordx4 v10, s[16:19], s37 offen sc1 lds
  s_add_u32 m0, s67, 96256
  s_nop 0
  buffer_load_dwordx4 v10, s[16:19], s30 offen offset:0 sc1 lds
  buffer_load_dwordx4 v10, s[16:19], s30 offen offset:1024 sc1 lds
  buffer_load_dwordx4 v10, s[16:19], s30 offen offset:2048 sc1 lds
  s_cbranch_vccnz Lsk_27
  buffer_load_dwordx4 v10, s[16:19], s30 offen offset:3072 sc1 lds
Lsk_27:
  s_add_u32 s30, s30, 221184
  s_add_u32 m0, s35, 73728
  s_nop 0
  buffer_load_dwordx4 v8, s[4:7], s29 offen lds
  buffer_load_dwordx4 v9, s[4:7], s29 offen offset:1024 lds
  s_add_u32 s29, s29, 128
  s_waitcnt vmcnt(20)
  s_barrier
  s_add_u32 m0, s32, 2048
  s_add_u32 s37, s31, 40960
  buffer_load_dwordx4 v10, s[16:19], s37 offen sc1 lds
  s_add_u32 m0, s67, 110592
  s_nop 0
  buffer_load_dwordx4 v10, s[16:19], s30 offen offset:0 sc1 lds
  buffer_load_dwordx4 v10, s[16:19], s30 offen offset:1024 sc1 lds
  buffer_load_dwordx4 v10, s[16:19], s30 offen offset:2048 sc1 lds
  s_cbranch_vccnz Lsk_28
  buffer_load_dwordx4 v10, s[16:19], s30 offen offset:3072 sc1 lds
Lsk_28:
  s_add_u32 s30, s30, 221184
  s_add_u32 m0, s35, 32768
  s_nop 0
  buffer_load_dwordx4 v8, s[4:7], s29 offen lds
  buffer_load_dwordx4 v9, s[4:7], s29 offen offset:1024 lds
  s_add_u32 s29, s29, 128
  s_waitcnt vmcnt(20)
  s_barrier
  s_add_u32 m0, s32, 3072
  s_add_u32 s37, s31, 163840
  buffer_load_dwordx4 v10, s[16:19], s37 offen sc1 lds
  s_add_u32 m0, s67, 124928
  s_nop 0
  buffer_load_dwordx4 v10, s[16:19], s30 offen offset:0 sc1 lds
  buffer_load_dwordx4 v10, s[16:19], s30 offen offset:1024 sc1 lds
  buffer_load_dwordx4 v10, s[16:19], s30 offen offset:2048 sc1 lds
  s_cbranch_vccnz Lsk_29
  buffer_load_dwordx4 v10, s[16:19], s30 offen offset:3072 sc1 lds
Lsk_29:
  s_add_u32 s30, s30, 221184
  s_add_u32 m0, s35, 40960
  s_nop 0
  buffer_load_dwordx4 v8, s[4:7], s29 offen lds
  buffer_load_dwordx4 v9, s[4:7], s29 offen offset:1024 lds
  s_add_u32 s29, s29, 128
  v_lshrrev_b32 v1, 5, v0
  v_and_b32 v2, 31, v0
  s_lshl_b32 s42, s25, 2
  s_add_u32 s42, s42, s26
  s_mul_i32 s44, s42, 2560
  s_add_u32 s44, s44, 0x1680000
  s_lshl_b32 s43, s42, 7
  s_add_u32 s43, s43, 0x1694000
  s_lshl_b32 s59, s24, 7
  s_add_u32 s59, s59, 0x1695000
  s_waitcnt vmcnt(21)
  s_barrier
  s_add_u32 m0, s32, 4096
  s_add_u32 s37, s31, 1024
  buffer_load_dwordx4 v18, s[16:19], s37 offen sc1 lds
  s_add_u32 m0, s67, 139264
  s_nop 0
  buffer_load_dwordx4 v10, s[16:19], s30 offen offset:0 sc1 lds
  buffer_load_dwordx4 v10, s[16:19], s30 offen offset:1024 sc1 lds
  buffer_load_dwordx4 v10, s[16:19], s30 offen offset:2048 sc1 lds
  s_cbranch_vccnz Lsk_30
  buffer_load_dwordx4 v10, s[16:19], s30 offen offset:3072 sc1 lds
Lsk_30:
  s_add_u32 s30, s30, 221184
  s_add_u32 m0, s35, 49152
  s_nop 0
  buffer_load_dwordx4 v8, s[4:7], s29 offen lds
  buffer_load_dwordx4 v9, s[4:7], s29 offen offset:1024 lds
  s_add_u32 s29, s29, 128
  s_add_u32 s8, s52, 0xe80000
  s_addc_u32 s9, s53, 0
  s_and_b32 s9, s9, 0xffff
  s_mov_b32 s10, 0x5e0000
  s_mov_b32 s11, 0x20000
  s_add_u32 s12, s52, 0x1480000
  s_addc_u32 s13, s53, 0
  s_and_b32 s13, s13, 0xffff
  s_mov_b32 s14, 0x1d6000
  s_mov_b32 s15, 0x20000
  s_lshl_b32 s36, s24, 1
  s_add_u32 s36, s36, s28
  s_mul_i32 s56, s36, 94
  s_lshl_b32 s36, s27, 1
  s_add_u32 s56, s56, s36
  s_lshl_b32 s56, s56, 10
  s_mul_i32 s36, s27, 3
  s_mul_i32 s57, s28, 40
  s_add_u32 s57, s57, s36
  s_mul_i32 s37, s25, 5
  s_add_u32 s57, s57, s37
  s_lshl_b32 s57, s57, 10
  s_mul_i32 s58, s28, 5
  s_add_u32 s58, s58, s36
  s_lshl_b32 s58, s58, 10
  s_waitcnt vmcnt(20)
  s_barrier
  s_add_u32 m0, s67, 81920
  s_nop 0
  buffer_load_dwordx4 v10, s[16:19], s30 offen offset:0 sc1 lds
  buffer_load_dwordx4 v10, s[16:19], s30 offen offset:1024 sc1 lds
  buffer_load_dwordx4 v10, s[16:19], s30 offen offset:2048 sc1 lds
  s_cbranch_vccnz Lsk_31
  buffer_load_dwordx4 v10, s[16:19], s30 offen offset:3072 sc1 lds
Lsk_31:
  s_add_u32 s30, s30, 221184
  s_add_u32 m0, s35, 57344
  s_nop 0
  buffer_load_dwordx4 v8, s[4:7], s29 offen lds
  buffer_load_dwordx4 v9, s[4:7], s29 offen offset:1024 lds
  s_add_u32 s29, s29, 128
  s_waitcnt vmcnt(19)
  s_barrier
  s_mul_i32 s37, s24, 245760
  s_mul_i32 s36, s42, 1280
  s_add_u32 s37, s37, s36
  s_add_u32 s38, s37, 122880
  v_lshlrev_b32 v26, 3, v2
  v_lshl_add_u32 v26, v1, 9, v26
  buffer_load_dwordx2 v[36:37], v26, s[16:19], s37 offen offset:0 sc1
  buffer_load_dwordx2 v[42:43], v26, s[16:19], s38 offen offset:0 sc1
  s_add_u32 m0, s67, 96256
  s_nop 0
  buffer_load_dwordx4 v10, s[16:19], s30 offen offset:0 sc1 lds
  buffer_load_dwordx4 v10, s[16:19], s30 offen offset:1024 sc1 lds
  buffer_load_dwordx4 v10, s[16:19], s30 offen offset:2048 sc1 lds
  s_cbranch_vccnz Lsk_32
  buffer_load_dwordx4 v10, s[16:19], s30 offen offset:3072 sc1 lds
Lsk_32:
  s_add_u32 s30, s30, 221184
  s_add_u32 m0, s35, 65536
  s_nop 0
  buffer_load_dwordx4 v8, s[4:7], s29 offen lds
  buffer_load_dwordx4 v9, s[4:7], s29 offen offset:1024 lds
  s_add_u32 s29, s29, 128
  v_bfe_u32 v3, v0, 2, 2
  v_lshl_add_u32 v3, v1, 3, v3
  v_lshlrev_b32 v3, 3, v3
  v_add_u32 v3, s32, v3
  v_and_b32 v6, 3, v0
  v_lshl_add_u32 v6, v6, 8, v3
  v_add_u32 v7, 4096, v3
  v_and_b32 v5, 16, v0
  v_cmp_eq_u32 s[46:47], 0, v5
  s_nop 1
  v_cndmask_b32 v112, v7, v6, s[46:47]
  v_add_u32 v6, 1024, v6
  v_add_u32 v7, 256, v7
  v_cndmask_b32 v113, v7, v6, s[46:47]
  v_add_u32 v6, 1024, v6
  v_add_u32 v7, 256, v7
  v_cndmask_b32 v114, v7, v6, s[46:47]
  v_add_u32 v6, 1024, v6
  v_add_u32 v7, 256, v7
  v_cndmask_b32 v115, v7, v6, s[46:47]
  v_add_u32 v6, 1024, v6
  v_add_u32 v7, 256, v7
  v_mov_b32 v19, 0x3f803f80
  v_lshlrev_b32 v3, 9, v1
  v_lshl_add_u32 v3, v2, 2, v3
  s_lshl_b32 s36, s25, 2
  s_add_u32 s36, s36, s64
  s_mul_i32 s65, s36, 2560
  s_lshl_b32 s37, s26, 10
  s_add_u32 s65, s65, s37
  s_add_u32 s65, s65, 0x1680000
  s_cmp_eq_u32 s26, 3
  s_cselect_b32 s65, 0x40000000, s65
  s_lshl_b32 s66, s36, 7
  s_add_u32 s66, s66, 0x1694000
  v_add_u32 v4, s32, v10
  v_add_u32 v5, s37, v10
  s_waitcnt vmcnt(20)
  s_barrier
  s_add_u32 m0, s67, 110592
  s_nop 0
  buffer_load_dwordx4 v10, s[16:19], s30 offen offset:0 sc1 lds
  buffer_load_dwordx4 v10, s[16:19], s30 offen offset:1024 sc1 lds
  buffer_load_dwordx4 v10, s[16:19], s30 offen offset:2048 sc1 lds
  s_cbranch_vccnz Lsk_33
  buffer_load_dwordx4 v10, s[16:19], s30 offen offset:3072 sc1 lds
Lsk_33:
  s_add_u32 s30, s30, 221184
  s_add_u32 m0, s35, 73728
  s_nop 0
  buffer_load_dwordx4 v8, s[4:7], s29 offen lds
  buffer_load_dwordx4 v9, s[4:7], s29 offen offset:1024 lds
  s_add_u32 s29, s29, 128
  v_cmp_eq_u32 s[46:47], 20, v2
  s_waitcnt vmcnt(22)
  ds_read_b64_tr_b16 v[48:49], v112 offset:0
  ds_read_b64_tr_b16 v[50:51], v112 offset:32
  ds_read_b64_tr_b16 v[52:53], v112 offset:128
  ds_read_b64_tr_b16 v[54:55], v112 offset:160
  ds_read_b64_tr_b16 v[56:57], v113 offset:0
  ds_read_b64_tr_b16 v[58:59], v113 offset:32
  ds_read_b64_tr_b16 v[60:61], v113 offset:128
  ds_read_b64_tr_b16 v[62:63], v113 offset:160
  ds_read_b64_tr_b16 v[64:65], v114 offset:0
  ds_read_b64_tr_b16 v[66:67], v114 offset:32
  ds_read_b64_tr_b16 v[68:69], v114 offset:128
  ds_read_b64_tr_b16 v[70:71], v114 offset:160
  ds_read_b64_tr_b16 v[72:73], v115 offset:0
  ds_read_b64_tr_b16 v[74:75], v115 offset:32
  ds_read_b64_tr_b16 v[76:77], v115 offset:128
  ds_read_b64_tr_b16 v[78:79], v115 offset:160
  s_waitcnt lgkmcnt(0)
  v_cndmask_b32 v64, v64, v19, s[46:47]
  v_cndmask_b32 v65, v65, v19, s[46:47]
  v_cndmask_b32 v66, v66, v19, s[46:47]
  v_cndmask_b32 v67, v67, v19, s[46:47]
  v_cndmask_b32 v68, v68, v19, s[46:47]
  v_cndmask_b32 v69, v69, v19, s[46:47]
  v_cndmask_b32 v70, v70, v19, s[46:47]
  v_cndmask_b32 v71, v71, v19, s[46:47]
  v_cndmask_b32 v72, v72, v19, s[46:47]
  v_cndmask_b32 v73, v73, v19, s[46:47]
  v_cndmask_b32 v74, v74, v19, s[46:47]
  v_cndmask_b32 v75, v75, v19, s[46:47]
  v_cndmask_b32 v76, v76, v19, s[46:47]
  v_cndmask_b32 v77, v77, v19, s[46:47]
  v_cndmask_b32 v78, v78, v19, s[46:47]
  v_cndmask_b32 v79, v79, v19, s[46:47]
  v_mfma_f32_32x32x16_bf16 v[80:95], v[48:51], v[64:67], 0
  v_mfma_f32_32x32x16_bf16 v[80:95], v[52:55], v[68:71], v[80:95]
  v_mfma_f32_32x32x16_bf16 v[80:95], v[56:59], v[72:75], v[80:95]
  v_mfma_f32_32x32x16_bf16 v[80:95], v[60:63], v[76:79], v[80:95]
  s_nop 11
  ds_write_b128 v4, v[80:83] offset:0
  ds_write_b128 v4, v[84:87] offset:1024
  ds_write_b128 v4, v[88:91] offset:2048
  s_waitcnt lgkmcnt(0)
  s_waitcnt vmcnt(19)
  s_barrier
  s_mul_i32 s37, s24, 245760
  s_mul_i32 s36, s42, 1280
  s_add_u32 s37, s37, s36
  s_add_u32 s38, s37, 122880
  v_lshlrev_b32 v26, 3, v2
  v_lshl_add_u32 v26, v1, 9, v26
  buffer_load_dwordx2 v[38:39], v26, s[16:19], s37 offen offset:256 sc1
  buffer_load_dwordx2 v[44:45], v26, s[16:19], s38 offen offset:256 sc1
  s_add_u32 m0, s67, 124928
  s_nop 0
  buffer_load_dwordx4 v10, s[16:19], s30 offen offset:0 sc1 lds
  buffer_load_dwordx4 v10, s[16:19], s30 offen offset:1024 sc1 lds
  buffer_load_dwordx4 v10, s[16:19], s30 offen offset:2048 sc1 lds
  s_cbranch_vccnz Lsk_34
  buffer_load_dwordx4 v10, s[16:19], s30 offen offset:3072 sc1 lds
Lsk_34:
  s_add_u32 s30, s30, 221184
  s_add_u32 m0, s35, 32768
  s_nop 0
  buffer_load_dwordx4 v8, s[4:7], s29 offen lds
  buffer_load_dwordx4 v9, s[4:7], s29 offen offset:1024 lds
  s_add_u32 s29, s29, 128
  ds_read_b128 v[48:51], v5 offset:0
  ds_read_b128 v[52:55], v5 offset:8192
  ds_read_b128 v[56:59], v5 offset:16384
  ds_read_b128 v[60:63], v5 offset:24576
  s_waitcnt lgkmcnt(0)
  v_add_f32 v48, v48, v52
  v_add_f32 v56, v56, v60
  v_add_f32 v49, v49, v53
  v_add_f32 v57, v57, v61
  v_add_f32 v50, v50, v54
  v_add_f32 v58, v58, v62
  v_add_f32 v51, v51, v55
  v_add_f32 v59, v59, v63
  v_add_f32 v48, v48, v56
  v_add_f32 v49, v49, v57
  v_add_f32 v50, v50, v58
  v_add_f32 v51, v51, v59
  s_cmp_eq_u32 s26, 2
  s_cselect_b32 exec_hi, 0, 0x1fffff
  s_mov_b32 exec_lo, 0x1fffff
  buffer_atomic_add_f32 v48, v3, s[16:19], s65 offen offset:0
  buffer_atomic_add_f32 v49, v3, s[16:19], s65 offen offset:128
  buffer_atomic_add_f32 v50, v3, s[16:19], s65 offen offset:256
  buffer_atomic_add_f32 v51, v3, s[16:19], s65 offen offset:384
  s_mov_b64 exec, -1
  s_waitcnt vmcnt(25)
  s_barrier
  s_add_u32 m0, s67, 139264
  s_nop 0
  buffer_load_dwordx4 v10, s[16:19], s30 offen offset:0 sc1 lds
  buffer_load_dwordx4 v10, s[16:19], s30 offen offset:1024 sc1 lds
  buffer_load_dwordx4 v10, s[16:19], s30 offen offset:2048 sc1 lds
  s_cbranch_vccnz Lsk_35
  buffer_load_dwordx4 v10, s[16:19], s30 offen offset:3072 sc1 lds
Lsk_35:
  s_add_u32 s30, s30, 221184
  s_add_u32 m0, s35, 40960
  s_nop 0
  buffer_load_dwordx4 v8, s[4:7], s29 offen lds
  buffer_load_dwordx4 v9, s[4:7], s29 offen offset:1024 lds
  s_add_u32 s29, s29, 128
  s_mul_i32 s36, s26, 5
  v_add_u32 v27, s36, v1
  v_and_b32 v28, 1, v27
  v_lshl_add_u32 v28, v28, 5, v2
  v_lshlrev_b32 v28, 4, v28
  v_bfe_u32 v29, v27, 1, 1
  v_lshl_add_u32 v28, v29, 3, v28
  v_lshrrev_b32 v29, 2, v27
  v_lshl_add_u32 v30, v29, 10, v28
  v_add_u32 v27, 2, v27
  v_and_b32 v28, 1, v27
  v_lshl_add_u32 v28, v28, 5, v2
  v_lshlrev_b32 v28, 4, v28
  v_bfe_u32 v29, v27, 1, 1
  v_lshl_add_u32 v28, v29, 3, v28
  v_lshrrev_b32 v29, 2, v27
  v_lshl_add_u32 v31, v29, 10, v28
  s_add_u32 s36, s36, 4
  v_mov_b32 v27, s36
  v_and_b32 v28, 1, v27
  v_lshl_add_u32 v28, v28, 5, v2
  v_lshlrev_b32 v28, 4, v28
  v_bfe_u32 v29, v27, 1, 1
  v_lshl_add_u32 v28, v29, 3, v28
  v_lshrrev_b32 v29, 2, v27
  v_lshl_add_u32 v32, v29, 10, v28
  v_add_u32 v30, 153600, v30
  v_add_u32 v31, 153600, v31
  v_add_u32 v32, 153600, v32
  s_lshl_b32 s36, s26, 10
  v_add_u32 v11, s36, v10
  s_lshl_b32 s36, s26, 8
  s_add_u32 s36, s36, 4096
  v_add_u32 v12, s36, v10
  v_add_u32 v13, 153600, v11
  v_add_u32 v14, 153600, v12
  v_add_u32 v27, 0, v0
  v_min_u32 v27, 159, v27
  v_mul_u32_u24 v28, 205, v27
  v_lshrrev_b32 v28, 11, v28
  v_mul_u32_u24 v28, 1120, v28
  v_lshl_add_u32 v15, v27, 4, v28
  v_add_u32 v27, 64, v0
  v_min_u32 v27, 159, v27
  v_mul_u32_u24 v28, 205, v27
  v_lshrrev_b32 v28, 11, v28
  v_mul_u32_u24 v28, 1120, v28
  v_lshl_add_u32 v16, v27, 4, v28
  v_subrev_u32 v16, 1024, v16
  v_add_u32 v27, 128, v0
  v_min_u32 v27, 159, v27
  v_mul_u32_u24 v28, 205, v27
  v_lshrrev_b32 v28, 11, v28
  v_mul_u32_u24 v28, 1120, v28
  v_lshl_add_u32 v17, v27, 4, v28
  v_subrev_u32 v17, 2048, v17
  s_mov_b32 s20, s54
  s_and_b32 s21, s55, 0xffff
  s_mov_b32 s22, 0x280000
  s_mov_b32 s23, 0x20000
  s_lshl_b32 s36, s24, 2
  s_add_u32 s36, s36, s26
  s_mul_i32 s60, s36, 20480
  s_mul_i32 s36, s25, 160
  s_add_u32 s60, s60, s36
  s_lshl_b32 s61, s26, 12
  v_cmp_eq_u32 s[46:47], 24, v2
  s_nop 1
  v_cndmask_b32 v33, v2, 20, s[46:47]
  v_lshlrev_b32 v33, 2, v33
  v_lshl_add_u32 v34, v1, 10, v33
  v_lshl_add_u32 v33, v1, 30, v33
  s_waitcnt vmcnt(23)
  s_barrier
  s_mul_i32 s37, s24, 245760
  s_mul_i32 s36, s42, 1280
  s_add_u32 s37, s37, s36
  s_add_u32 s38, s37, 122880
  v_lshlrev_b32 v26, 3, v2
  buffer_load_dwordx2 v[40:41], v26, s[16:19], s37 offen offset:1024 sc1
  buffer_load_dwordx2 v[46:47], v26, s[16:19], s38 offen offset:1024 sc1
  s_add_u32 m0, s67, 81920
  s_nop 0
  buffer_load_dwordx4 v10, s[16:19], s30 offen offset:0 sc1 lds
  buffer_load_dwordx4 v10, s[16:19], s30 offen offset:1024 sc1 lds
  buffer_load_dwordx4 v10, s[16:19], s30 offen offset:2048 sc1 lds
  s_cbranch_vccnz Lsk_36
  buffer_load_dwordx4 v10, s[16:19], s30 offen offset:3072 sc1 lds
Lsk_36:
  s_add_u32 s30, s30, 221184
  s_add_u32 m0, s35, 49152
  s_nop 0
  buffer_load_dwordx4 v8, s[4:7], s29 offen lds
  buffer_load_dwordx4 v9, s[4:7], s29 offen offset:1024 lds
  s_add_u32 s29, s29, 128
  s_waitcnt vmcnt(12)
  v_mov_b32 v24, 1
  v_mov_b32 v25, 0
  s_mov_b64 exec, 1
  buffer_atomic_add v24, v25, s[16:19], s66 offen offset:0 sc1
  s_mov_b64 exec, -1
  s_waitcnt vmcnt(26)
  s_barrier
  s_lshl_b32 s36, s24, 1
  s_add_u32 s36, s36, s28
  s_mul_i32 s33, s36, 108
  s_mul_i32 s36, s25, 7
  s_add_u32 s33, s33, s36
  s_lshl_b32 s36, s27, 2
  s_add_u32 s33, s33, s36
  s_lshl_b32 s33, s33, 10
  s_add_u32 s33, s33, 0x780000
  s_add_u32 m0, s67, 16384
  s_nop 0
  buffer_load_dwordx4 v10, s[16:19], s33 offen offset:0 sc1 lds
  s_add_u32 m0, s67, 96256
  s_nop 0
  buffer_load_dwordx4 v10, s[16:19], s30 offen offset:0 sc1 lds
  buffer_load_dwordx4 v10, s[16:19], s30 offen offset:1024 sc1 lds
  buffer_load_dwordx4 v10, s[16:19], s30 offen offset:2048 sc1 lds
  s_cbranch_vccnz Lsk_38
  buffer_load_dwordx4 v10, s[16:19], s30 offen offset:3072 sc1 lds
Lsk_38:
  s_add_u32 s30, s30, 221184
  s_add_u32 m0, s35, 57344
  s_nop 0
  buffer_load_dwordx4 v8, s[4:7], s29 offen lds
  buffer_load_dwordx4 v9, s[4:7], s29 offen offset:1024 lds
  s_add_u32 s29, s29, 128
  s_waitcnt vmcnt(25)
  s_barrier
  s_add_u32 m0, s67, 110592
  s_nop 0
  buffer_load_dwordx4 v10, s[16:19], s30 offen offset:0 sc1 lds
  buffer_load_dwordx4 v10, s[16:19], s30 offen offset:1024 sc1 lds
  buffer_load_dwordx4 v10, s[16:19], s30 offen offset:2048 sc1 lds
  s_cbranch_vccnz Lsk_39
  buffer_load_dwordx4 v10, s[16:19], s30 offen offset:3072 sc1 lds
Lsk_39:
  s_add_u32 s30, s30, 221184
  s_add_u32 m0, s35, 65536
  s_nop 0
  buffer_load_dwordx4 v8, s[4:7], s29 offen lds
  buffer_load_dwordx4 v9, s[4:7], s29 offen offset:1024 lds
  s_add_u32 s29, s29, 128
  s_mov_b32 m0, s61
  s_nop 0
  buffer_load_dwordx4 v15, s[20:23], s60 offen offset:0 lds
  s_waitcnt vmcnt(22)
  s_barrier
  s_add_u32 m0, s67, 16384
  s_nop 0
  buffer_load_dwordx4 v10, s[16:19], s33 offen offset:1024 sc1 lds
  s_add_u32 m0, s67, 124928
  s_nop 0
  buffer_load_dwordx4 v10, s[16:19], s30 offen offset:0 sc1 lds
  buffer_load_dwordx4 v10, s[16:19], s30 offen offset:1024 sc1 lds
  buffer_load_dwordx4 v10, s[16:19], s30 offen offset:2048 sc1 lds
  s_cbranch_vccnz Lsk_41
  buffer_load_dwordx4 v10, s[16:19], s30 offen offset:3072 sc1 lds
Lsk_41:
  s_add_u32 s30, s30, 221184
  s_add_u32 m0, s35, 73728
  s_nop 0
  buffer_load_dwordx4 v8, s[4:7], s29 offen lds
  buffer_load_dwordx4 v9, s[4:7], s29 offen offset:1024 lds
  s_add_u32 s29, s29, 128
  s_waitcnt vmcnt(21)
  s_barrier
  v_mov_b32 v24, 0
  buffer_load_dword v20, v24, s[16:19], s43 offen offset:0 sc1
  s_add_u32 m0, s67, 139264
  s_nop 0
  buffer_load_dwordx4 v10, s[16:19], s30 offen offset:0 sc1 lds
  buffer_load_dwordx4 v10, s[16:19], s30 offen offset:1024 sc1 lds
  buffer_load_dwordx4 v10, s[16:19], s30 offen offset:2048 sc1 lds
  s_cbranch_vccnz Lsk_42
  buffer_load_dwordx4 v10, s[16:19], s30 offen offset:3072 sc1 lds
Lsk_42:
  s_add_u32 s30, s30, 221184
  s_add_u32 m0, s35, 32768
  s_nop 0
  buffer_load_dwordx4 v8, s[4:7], s29 offen lds
  buffer_load_dwordx4 v9, s[4:7], s29 offen offset:1024 lds
  s_add_u32 s29, s29, 128
  s_waitcnt vmcnt(20)
  s_barrier
  s_add_u32 m0, s67, 81920
  s_nop 0
  buffer_load_dwordx4 v10, s[16:19], s30 offen offset:0 sc1 lds
  buffer_load_dwordx4 v10, s[16:19], s30 offen offset:1024 sc1 lds
  buffer_load_dwordx4 v10, s[16:19], s30 offen offset:2048 sc1 lds
  s_cbranch_vccnz Lsk_43
  buffer_load_dwordx4 v10, s[16:19], s30 offen offset:3072 sc1 lds
Lsk_43:
  s_add_u32 s30, s30, 221184
  s_add_u32 m0, s35, 40960
  s_nop 0
  buffer_load_dwordx4 v8, s[4:7], s29 offen lds
  buffer_load_dwordx4 v9, s[4:7], s29 offen offset:1024 lds
  s_add_u32 s29, s29, 128
  s_mov_b32 m0, s61
  s_nop 0
  buffer_load_dwordx4 v16, s[20:23], s60 offen offset:1024 lds
  s_waitcnt vmcnt(21)
  s_barrier
  s_waitcnt vmcnt(11)
Lchk_44:
  v_readfirstlane_b32 s36, v20
  s_nop 0
  s_cmp_eq_u32 s36, 32
  s_cbranch_scc1 Lok_45
  v_mov_b32 v24, 0
  buffer_load_dword v20, v24, s[16:19], s43 offen offset:0 sc1
  s_waitcnt vmcnt(0)
  s_branch Lchk_44
Lok_45:
  buffer_load_dword v48, v34, s[16:19], s44 offen offset:0 sc1
  buffer_load_dword v49, v34, s[16:19], s44 offen offset:128 sc1
  buffer_load_dword v50, v34, s[16:19], s44 offen offset:256 sc1
  buffer_load_dword v51, v34, s[16:19], s44 offen offset:384 sc1
  buffer_load_dword v52, v34, s[16:19], s44 offen offset:512 sc1
  buffer_load_dword v53, v34, s[16:19], s44 offen offset:640 sc1
  buffer_load_dword v54, v34, s[16:19], s44 offen offset:768 sc1
  buffer_load_dword v55, v34, s[16:19], s44 offen offset:896 sc1
  buffer_load_dword v56, v33, s[16:19], s44 offen offset:2048 sc1
  buffer_load_dword v57, v33, s[16:19], s44 offen offset:2176 sc1
  buffer_load_dword v58, v33, s[16:19], s44 offen offset:2304 sc1
  buffer_load_dword v59, v33, s[16:19], s44 offen offset:2432 sc1
  s_add_u32 m0, s67, 96256
  s_nop 0
  buffer_load_dwordx4 v10, s[16:19], s30 offen offset:0 sc1 lds
  buffer_load_dwordx4 v10, s[16:19], s30 offen offset:1024 sc1 lds
  buffer_load_dwordx4 v10, s[16:19], s30 offen offset:2048 sc1 lds
  s_cbranch_vccnz Lsk_46
  buffer_load_dwordx4 v10, s[16:19], s30 offen offset:3072 sc1 lds
Lsk_46:
  s_add_u32 s30, s30, 221184
  s_add_u32 m0, s35, 49152
  s_nop 0
  buffer_load_dwordx4 v8, s[4:7], s29 offen lds
  buffer_load_dwordx4 v9, s[4:7], s29 offen offset:1024 lds
  s_add_u32 s29, s29, 128
  s_waitcnt vmcnt(31)
  s_barrier
  s_add_u32 m0, s67, 16384
  s_nop 0
  buffer_load_dwordx4 v10, s[16:19], s33 offen offset:2048 sc1 lds
  s_add_u32 m0, s67, 110592
  s_nop 0
  buffer_load_dwordx4 v10, s[16:19], s30 offen offset:0 sc1 lds
  buffer_load_dwordx4 v10, s[16:19], s30 offen offset:1024 sc1 lds
  buffer_load_dwordx4 v10, s[16:19], s30 offen offset:2048 sc1 lds
  s_cbranch_vccnz Lsk_48
  buffer_load_dwordx4 v10, s[16:19], s30 offen offset:3072 sc1 lds
Lsk_48:
  s_add_u32 s30, s30, 221184
  s_add_u32 m0, s35, 57344
  s_nop 0
  buffer_load_dwordx4 v8, s[4:7], s29 offen lds
  buffer_load_dwordx4 v9, s[4:7], s29 offen offset:1024 lds
  s_add_u32 s29, s29, 128
  s_waitcnt vmcnt(31)
  s_barrier
  s_add_u32 m0, s67, 124928
  s_nop 0
  buffer_load_dwordx4 v10, s[16:19], s30 offen offset:0 sc1 lds
  buffer_load_dwordx4 v10, s[16:19], s30 offen offset:1024 sc1 lds
  buffer_load_dwordx4 v10, s[16:19], s30 offen offset:2048 sc1 lds
  s_cbranch_vccnz Lsk_49
  buffer_load_dwordx4 v10, s[16:19], s30 offen offset:3072 sc1 lds
Lsk_49:
  s_add_u32 s30, s30, 221184
  s_add_u32 m0, s35, 65536
  s_nop 0
  buffer_load_dwordx4 v8, s[4:7], s29 offen lds
  buffer_load_dwordx4 v9, s[4:7], s29 offen offset:1024 lds
  s_add_u32 s29, s29, 128
  s_mul_i32 s37, s24, 192512
  s_mul_i32 s38, s25, 5120
  s_add_u32 s37, s37, s38
  s_add_u32 s37, s37, 0xe80000
  s_add_u32 s38, s37, 96256
  v_cmp_eq_u32 s[46:47], 1, v1
  s_waitcnt vmcnt(16) lgkmcnt(0)
  v_cvt_pk_bf16_f32 v64, v48, v49
  v_cvt_pk_bf16_f32 v65, v50, v51
  v_cvt_pk_bf16_f32 v66, v52, v53
  v_cvt_pk_bf16_f32 v67, v54, v55
  v_cvt_pk_bf16_f32 v68, v56, v57
  v_cvt_pk_bf16_f32 v69, v58, v59
  v_mfma_f32_32x32x16_bf16 v[80:95], v[64:67], v[36:39], 0
  s_nop 0
  v_mfma_f32_32x32x8_bf16 v[80:95], v[68:69], v[40:41], v[80:95]
  v_mfma_f32_32x32x16_bf16 v[96:111], v[64:67], v[42:45], 0
  v_mfma_f32_32x32x8_bf16 v[96:111], v[68:69], v[46:47], v[96:111]
  s_nop 9
  v_cndmask_b32 v24, v92, v88, s[46:47]
  v_add_f32 v24, 0x358637bd, v24
  v_rcp_f32 v24, v24
  s_nop 0
  v_mul_f32 v80, v80, v24
  v_mul_f32 v81, v81, v24
  v_mul_f32 v82, v82, v24
  v_mul_f32 v83, v83, v24
  v_mul_f32 v84, v84, v24
  v_mul_f32 v85, v85, v24
  v_mul_f32 v86, v86, v24
  v_mul_f32 v87, v87, v24
  v_mul_f32 v88, v88, v24
  v_mul_f32 v89, v89, v24
  v_mul_f32 v90, v90, v24
  v_mul_f32 v91, v91, v24
  v_cvt_pk_bf16_f32 v48, v80, v81
  v_cvt_pk_bf16_f32 v49, v82, v83
  v_cvt_pk_bf16_f32 v50, v84, v85
  v_cvt_pk_bf16_f32 v51, v86, v87
  v_cvt_pk_bf16_f32 v52, v88, v89
  v_cvt_pk_bf16_f32 v53, v90, v91
  v_cndmask_b32 v24, v108, v104, s[46:47]
  v_add_f32 v24, 0x358637bd, v24
  v_rcp_f32 v24, v24
  s_nop 0
  v_mul_f32 v96, v96, v24
  v_mul_f32 v97, v97, v24
  v_mul_f32 v98, v98, v24
  v_mul_f32 v99, v99, v24
  v_mul_f32 v100, v100, v24
  v_mul_f32 v101, v101, v24
  v_mul_f32 v102, v102, v24
  v_mul_f32 v103, v103, v24
  v_mul_f32 v104, v104, v24
  v_mul_f32 v105, v105, v24
  v_mul_f32 v106, v106, v24
  v_mul_f32 v107, v107, v24
  v_cvt_pk_bf16_f32 v56, v96, v97
  v_cvt_pk_bf16_f32 v57, v98, v99
  v_cvt_pk_bf16_f32 v58, v100, v101
  v_cvt_pk_bf16_f32 v59, v102, v103
  v_cvt_pk_bf16_f32 v60, v104, v105
  v_cvt_pk_bf16_f32 v61, v106, v107
  ds_write_b64 v30, v[48:49] offset:0
  ds_write_b64 v30, v[56:57] offset:5120
  ds_write_b64 v31, v[50:51] offset:0
  ds_write_b64 v31, v[58:59] offset:5120
  s_mov_b32 exec_hi, 0
  ds_write_b64 v32, v[52:53] offset:0
  ds_write_b64 v32, v[60:61] offset:5120
  s_mov_b64 exec, -1
  s_waitcnt lgkmcnt(0)
  s_waitcnt vmcnt(31)
  s_barrier
  s_add_u32 m0, s67, 139264
  s_nop 0
  buffer_load_dwordx4 v10, s[16:19], s30 offen offset:0 sc1 lds
  buffer_load_dwordx4 v10, s[16:19], s30 offen offset:1024 sc1 lds
  buffer_load_dwordx4 v10, s[16:19], s30 offen offset:2048 sc1 lds
  s_cbranch_vccnz Lsk_50
  buffer_load_dwordx4 v10, s[16:19], s30 offen offset:3072 sc1 lds
Lsk_50:
  s_add_u32 s30, s30, 221184
  s_add_u32 m0, s35, 73728
  s_nop 0
  buffer_load_dwordx4 v8, s[4:7], s29 offen lds
  buffer_load_dwordx4 v9, s[4:7], s29 offen offset:1024 lds
  s_add_u32 s29, s29, 128
  ds_read_b128 v[80:83], v13 offset:0
  ds_read_b128 v[88:91], v13 offset:5120
  s_mov_b64 exec, 0xffff
  ds_read_b128 v[84:87], v14 offset:0
  ds_read_b128 v[92:95], v14 offset:5120
  s_waitcnt lgkmcnt(0)
  buffer_store_dwordx4 v[84:87], v12, s[16:19], s37 offen sc1
  buffer_store_dwordx4 v[92:95], v12, s[16:19], s38 offen sc1
  s_mov_b64 exec, -1
  buffer_store_dwordx4 v[80:83], v11, s[16:19], s37 offen sc1
  buffer_store_dwordx4 v[88:91], v11, s[16:19], s38 offen sc1
  s_waitcnt vmcnt(22)
  s_barrier
  s_add_u32 m0, s67, 81920
  s_nop 0
  buffer_load_dwordx4 v10, s[16:19], s30 offen offset:0 sc1 lds
  buffer_load_dwordx4 v10, s[16:19], s30 offen offset:1024 sc1 lds
  buffer_load_dwordx4 v10, s[16:19], s30 offen offset:2048 sc1 lds
  s_cbranch_vccnz Lsk_51
  buffer_load_dwordx4 v10, s[16:19], s30 offen offset:3072 sc1 lds
Lsk_51:
  s_add_u32 s30, s30, 221184
  s_add_u32 m0, s35, 32768
  s_nop 0
  buffer_load_dwordx4 v8, s[4:7], s29 offen lds
  buffer_load_dwordx4 v9, s[4:7], s29 offen offset:1024 lds
  s_add_u32 s29, s29, 128
  s_mov_b32 m0, s61
  s_nop 0
  buffer_load_dwordx4 v17, s[20:23], s60 offen offset:2048 lds
  s_waitcnt vmcnt(22)
  s_barrier
  s_cbranch_vccnz Lsk_52
  s_add_u32 m0, s67, 16384
  s_nop 0
  buffer_load_dwordx4 v10, s[16:19], s33 offen offset:3072 sc1 lds
Lsk_52:
  s_add_u32 m0, s67, 96256
  s_nop 0
  buffer_load_dwordx4 v10, s[16:19], s30 offen offset:0 sc1 lds
  buffer_load_dwordx4 v10, s[16:19], s30 offen offset:1024 sc1 lds
  buffer_load_dwordx4 v10, s[16:19], s30 offen offset:2048 sc1 lds
  s_cbranch_vccnz Lsk_53
  buffer_load_dwordx4 v10, s[16:19], s30 offen offset:3072 sc1 lds
Lsk_53:
  s_add_u32 s30, s30, 221184
  s_add_u32 m0, s35, 40960
  s_nop 0
  buffer_load_dwordx4 v8, s[4:7], s29 offen lds
  buffer_load_dwordx4 v9, s[4:7], s29 offen offset:1024 lds
  s_add_u32 s29, s29, 128
  s_waitcnt vmcnt(11)
  v_mov_b32 v24, 1
  v_mov_b32 v25, 0
  s_mov_b64 exec, 1
  buffer_atomic_add v24, v25, s[16:19], s59 offen offset:0 sc1
  s_mov_b64 exec, -1
  s_waitcnt vmcnt(23)
  s_barrier
  s_add_u32 m0, s67, 110592
  s_nop 0
  buffer_load_dwordx4 v10, s[16:19], s30 offen offset:0 sc1 lds
  buffer_load_dwordx4 v10, s[16:19], s30 offen offset:1024 sc1 lds
  buffer_load_dwordx4 v10, s[16:19], s30 offen offset:2048 sc1 lds
  s_cbranch_vccnz Lsk_54
  buffer_load_dwordx4 v10, s[16:19], s30 offen offset:3072 sc1 lds
Lsk_54:
  s_add_u32 s30, s30, 221184
  s_add_u32 m0, s35, 49152
  s_nop 0
  buffer_load_dwordx4 v8, s[4:7], s29 offen lds
  buffer_load_dwordx4 v9, s[4:7], s29 offen offset:1024 lds
  s_add_u32 s29, s29, 128
  s_waitcnt vmcnt(23)
  s_barrier
  s_add_u32 m0, s67, 124928
  s_nop 0
  buffer_load_dwordx4 v10, s[16:19], s30 offen offset:0 sc1 lds
  buffer_load_dwordx4 v10, s[16:19], s30 offen offset:1024 sc1 lds
  buffer_load_dwordx4 v10, s[16:19], s30 offen offset:2048 sc1 lds
  s_cbranch_vccnz Lsk_55
  buffer_load_dwordx4 v10, s[16:19], s30 offen offset:3072 sc1 lds
Lsk_55:
  s_add_u32 s30, s30, 221184
  s_add_u32 m0, s35, 57344
  s_nop 0
  buffer_load_dwordx4 v8, s[4:7], s29 offen lds
  buffer_load_dwordx4 v9, s[4:7], s29 offen offset:1024 lds
  s_add_u32 s29, s29, 128
  s_waitcnt vmcnt(19)
  s_barrier
  s_add_u32 m0, s67, 139264
  s_nop 0
  buffer_load_dwordx4 v10, s[16:19], s30 offen offset:0 sc1 lds
  buffer_load_dwordx4 v10, s[16:19], s30 offen offset:1024 sc1 lds
  buffer_load_dwordx4 v10, s[16:19], s30 offen offset:2048 sc1 lds
  s_cbranch_vccnz Lsk_56
  buffer_load_dwordx4 v10, s[16:19], s30 offen offset:3072 sc1 lds
Lsk_56:
  s_add_u32 s30, s30, 221184
  s_add_u32 m0, s58, 153600
  s_nop 0
  buffer_load_dwordx4 v10, s[12:15], s57 offen offset:0 sc1 lds
  buffer_load_dwordx4 v10, s[12:15], s57 offen offset:1024 sc1 lds
  s_cbranch_vccnz Lsk_57
  buffer_load_dwordx4 v10, s[12:15], s57 offen offset:2048 sc1 lds
Lsk_57:
  s_add_u32 s57, s57, 81920
  s_waitcnt vmcnt(18)
  s_barrier
  s_add_u32 m0, s58, 81920
  s_nop 0
  buffer_load_dwordx4 v10, s[12:15], s57 offen offset:0 sc1 lds
  buffer_load_dwordx4 v10, s[12:15], s57 offen offset:1024 sc1 lds
  s_cbranch_vccnz Lsk_58
  buffer_load_dwordx4 v10, s[12:15], s57 offen offset:2048 sc1 lds
Lsk_58:
  s_add_u32 s57, s57, 81920
  s_waitcnt vmcnt(14)
  s_barrier
  v_mov_b32 v24, 0
  buffer_load_dword v20, v24, s[16:19], s59 offen offset:0 sc1
  s_add_u32 m0, s58, 92160
  s_nop 0
  buffer_load_dwordx4 v10, s[12:15], s57 offen offset:0 sc1 lds
  buffer_load_dwordx4 v10, s[12:15], s57 offen offset:1024 sc1 lds
  s_cbranch_vccnz Lsk_59
  buffer_load_dwordx4 v10, s[12:15], s57 offen offset:2048 sc1 lds
Lsk_59:
  s_add_u32 s57, s57, 81920
  s_waitcnt vmcnt(12)
  s_barrier
  s_add_u32 m0, s58, 102400
  s_nop 0
  buffer_load_dwordx4 v10, s[12:15], s57 offen offset:0 sc1 lds
  buffer_load_dwordx4 v10, s[12:15], s57 offen offset:1024 sc1 lds
  s_cbranch_vccnz Lsk_60
  buffer_load_dwordx4 v10, s[12:15], s57 offen offset:2048 sc1 lds
Lsk_60:
  s_add_u32 s57, s57, 81920
  s_add_u32 m0, s58, 112640
  s_nop 0
  buffer_load_dwordx4 v10, s[12:15], s57 offen offset:0 sc1 lds
  buffer_load_dwordx4 v10, s[12:15], s57 offen offset:1024 sc1 lds
  s_cbranch_vccnz Lsk_61
  buffer_load_dwordx4 v10, s[12:15], s57 offen offset:2048 sc1 lds
Lsk_61:
  s_add_u32 s57, s57, 81920
  s_waitcnt vmcnt(6)
Lchk_62:
  v_readfirstlane_b32 s36, v20
  s_nop 0
  s_cmp_eq_u32 s36, 32
  s_cbranch_scc1 Lok_63
  v_mov_b32 v24, 0
  buffer_load_dword v20, v24, s[16:19], s59 offen offset:0 sc1
  s_waitcnt vmcnt(0)
  s_branch Lchk_62
Lok_63:
  s_add_u32 s59, s59, 4096
  s_add_u32 m0, s35, 65536
  s_nop 0
  buffer_load_dwordx4 v10, s[8:11], s56 offen offset:0 sc1 lds
  buffer_load_dwordx4 v10, s[8:11], s56 offen offset:1024 sc1 lds
  s_add_u32 s56, s56, 4096
  s_add_u32 m0, s35, 73728
  s_nop 0
  buffer_load_dwordx4 v10, s[8:11], s56 offen offset:0 sc1 lds
  buffer_load_dwordx4 v10, s[8:11], s56 offen offset:1024 sc1 lds
  s_add_u32 s56, s56, 4096
  s_add_u32 m0, s35, 32768
  s_nop 0
  buffer_load_dwordx4 v10, s[8:11], s56 offen offset:0 sc1 lds
  buffer_load_dwordx4 v10, s[8:11], s56 offen offset:1024 sc1 lds
  s_add_u32 s56, s56, 4096
  s_add_u32 m0, s35, 40960
  s_nop 0
  buffer_load_dwordx4 v10, s[8:11], s56 offen offset:0 sc1 lds
  buffer_load_dwordx4 v10, s[8:11], s56 offen offset:1024 sc1 lds
  s_add_u32 s56, s56, 4096
  s_waitcnt vmcnt(19)
  s_barrier
  s_add_u32 m0, s58, 122880
  s_nop 0
  buffer_load_dwordx4 v10, s[12:15], s57 offen offset:0 sc1 lds
  buffer_load_dwordx4 v10, s[12:15], s57 offen offset:1024 sc1 lds
  s_cbranch_vccnz Lsk_64
  buffer_load_dwordx4 v10, s[12:15], s57 offen offset:2048 sc1 lds
Lsk_64:
  s_add_u32 s57, s57, 81920
  s_add_u32 m0, s35, 49152
  s_nop 0
  buffer_load_dwordx4 v10, s[8:11], s56 offen offset:0 sc1 lds
  buffer_load_dwordx4 v10, s[8:11], s56 offen offset:1024 sc1 lds
  s_add_u32 s56, s56, 4096
  s_barrier
  s_add_u32 m0, s58, 133120
  s_nop 0
  buffer_load_dwordx4 v10, s[12:15], s57 offen offset:0 sc1 lds
  buffer_load_dwordx4 v10, s[12:15], s57 offen offset:1024 sc1 lds
  s_cbranch_vccnz Lsk_65
  buffer_load_dwordx4 v10, s[12:15], s57 offen offset:2048 sc1 lds
Lsk_65:
  s_add_u32 s57, s57, 81920
  s_add_u32 m0, s58, 143360
  s_nop 0
  buffer_load_dwordx4 v10, s[12:15], s57 offen offset:0 sc1 lds
  buffer_load_dwordx4 v10, s[12:15], s57 offen offset:1024 sc1 lds
  s_cbranch_vccnz Lsk_66
  buffer_load_dwordx4 v10, s[12:15], s57 offen offset:2048 sc1 lds
Lsk_66:
  s_add_u32 s57, s57, 81920
  s_add_u32 m0, s35, 57344
  s_nop 0
  buffer_load_dwordx4 v10, s[8:11], s56 offen offset:0 sc1 lds
  buffer_load_dwordx4 v10, s[8:11], s56 offen offset:1024 sc1 lds
  s_add_u32 s56, s56, 4096
  s_waitcnt vmcnt(16)
  s_barrier
  s_waitcnt vmcnt(14)
  s_barrier
  s_add_u32 m0, s58, 153600
  s_nop 0
  buffer_load_dwordx4 v10, s[12:15], s57 offen offset:0 sc1 lds
  buffer_load_dwordx4 v10, s[12:15], s57 offen offset:1024 sc1 lds
  s_cbranch_vccnz Lsk_67
  buffer_load_dwordx4 v10, s[12:15], s57 offen offset:2048 sc1 lds
Lsk_67:
  s_add_u32 s57, s57, 81920
  s_add_u32 m0, s35, 65536
  s_nop 0
  buffer_load_dwordx4 v10, s[8:11], s56 offen offset:0 sc1 lds
  buffer_load_dwordx4 v10, s[8:11], s56 offen offset:1024 sc1 lds
  s_add_u32 s56, s56, 4096
  s_waitcnt vmcnt(16)
  s_barrier
  s_add_u32 m0, s58, 81920
  s_nop 0
  buffer_load_dwordx4 v10, s[12:15], s57 offen offset:0 sc1 lds
  buffer_load_dwordx4 v10, s[12:15], s57 offen offset:1024 sc1 lds
  s_cbranch_vccnz Lsk_68
  buffer_load_dwordx4 v10, s[12:15], s57 offen offset:2048 sc1 lds
Lsk_68:
  s_add_u32 s57, s57, 81920
  s_add_u32 m0, s35, 73728
  s_nop 0
  buffer_load_dwordx4 v10, s[8:11], s56 offen offset:0 sc1 lds
  buffer_load_dwordx4 v10, s[8:11], s56 offen offset:1024 sc1 lds
  s_add_u32 s56, s56, 4096
  s_waitcnt vmcnt(18)
  s_barrier
  s_add_u32 m0, s58, 92160
  s_nop 0
  buffer_load_dwordx4 v10, s[12:15], s57 offen offset:0 sc1 lds
  buffer_load_dwordx4 v10, s[12:15], s57 offen offset:1024 sc1 lds
  s_cbranch_vccnz Lsk_69
  buffer_load_dwordx4 v10, s[12:15], s57 offen offset:2048 sc1 lds
Lsk_69:
  s_add_u32 s57, s57, 81920
  s_add_u32 m0, s35, 32768
  s_nop 0
  buffer_load_dwordx4 v10, s[8:11], s56 offen offset:0 sc1 lds
  buffer_load_dwordx4 v10, s[8:11], s56 offen offset:1024 sc1 lds
  s_add_u32 s56, s56, 4096
  s_waitcnt vmcnt(18)
  s_barrier
  s_add_u32 m0, s58, 102400
  s_nop 0
  buffer_load_dwordx4 v10, s[12:15], s57 offen offset:0 sc1 lds
  buffer_load_dwordx4 v10, s[12:15], s57 offen offset:1024 sc1 lds
  s_cbranch_vccnz Lsk_70
  buffer_load_dwordx4 v10, s[12:15], s57 offen offset:2048 sc1 lds
Lsk_70:
  s_add_u32 s57, s57, 81920
  s_add_u32 m0, s35, 40960
  s_nop 0
  buffer_load_dwordx4 v10, s[8:11], s56 offen offset:0 sc1 lds
  buffer_load_dwordx4 v10, s[8:11], s56 offen offset:1024 sc1 lds
  s_add_u32 s56, s56, 4096
  s_waitcnt vmcnt(16)
  s_barrier
  s_add_u32 m0, s58, 112640
  s_nop 0
  buffer_load_dwordx4 v10, s[12:15], s57 offen offset:0 sc1 lds
  buffer_load_dwordx4 v10, s[12:15], s57 offen offset:1024 sc1 lds
  s_cbranch_vccnz Lsk_71
  buffer_load_dwordx4 v10, s[12:15], s57 offen offset:2048 sc1 lds
Lsk_71:
  s_add_u32 s57, s57, 81920
  s_waitcnt vmcnt(14)
  s_barrier
  v_mov_b32 v24, 0
  buffer_load_dword v20, v24, s[16:19], s59 offen offset:0 sc1
  s_add_u32 m0, s58, 122880
  s_nop 0
  buffer_load_dwordx4 v10, s[12:15], s57 offen offset:0 sc1 lds
  buffer_load_dwordx4 v10, s[12:15], s57 offen offset:1024 sc1 lds
  s_cbranch_vccnz Lsk_72
  buffer_load_dwordx4 v10, s[12:15], s57 offen offset:2048 sc1 lds
Lsk_72:
  s_add_u32 s57, s57, 81920
  s_waitcnt vmcnt(13)
  s_barrier
  s_add_u32 m0, s58, 133120
  s_nop 0
  buffer_load_dwordx4 v10, s[12:15], s57 offen offset:0 sc1 lds
  buffer_load_dwordx4 v10, s[12:15], s57 offen offset:1024 sc1 lds
  s_cbranch_vccnz Lsk_73
  buffer_load_dwordx4 v10, s[12:15], s57 offen offset:2048 sc1 lds
Lsk_73:
  s_add_u32 s57, s57, 81920
  s_waitcnt vmcnt(11)
  s_barrier
  s_add_u32 m0, s58, 143360
  s_nop 0
  buffer_load_dwordx4 v10, s[12:15], s57 offen offset:0 sc1 lds
  buffer_load_dwordx4 v10, s[12:15], s57 offen offset:1024 sc1 lds
  s_cbranch_vccnz Lsk_74
  buffer_load_dwordx4 v10, s[12:15], s57 offen offset:2048 sc1 lds
Lsk_74:
  s_add_u32 s57, s57, 81920
  s_waitcnt vmcnt(6)
Lchk_75:
  v_readfirstlane_b32 s36, v20
  s_nop 0
  s_cmp_eq_u32 s36, 32
  s_cbranch_scc1 Lok_76
  v_mov_b32 v24, 0
  buffer_load_dword v20, v24, s[16:19], s59 offen offset:0 sc1
  s_waitcnt vmcnt(0)
  s_branch Lchk_75
Lok_76:
  s_add_u32 m0, s35, 49152
  s_nop 0
  buffer_load_dwordx4 v10, s[8:11], s56 offen offset:0 sc1 lds
  buffer_load_dwordx4 v10, s[8:11], s56 offen offset:1024 sc1 lds
  s_add_u32 s56, s56, 4096
  s_add_u32 m0, s35, 57344
  s_nop 0
  buffer_load_dwordx4 v10, s[8:11], s56 offen offset:0 sc1 lds
  buffer_load_dwordx4 v10, s[8:11], s56 offen offset:1024 sc1 lds
  s_add_u32 s56, s56, 4096
  s_add_u32 m0, s35, 65536
  s_nop 0
  buffer_load_dwordx4 v10, s[8:11], s56 offen offset:0 sc1 lds
  buffer_load_dwordx4 v10, s[8:11], s56 offen offset:1024 sc1 lds
  s_add_u32 s56, s56, 4096
  s_add_u32 m0, s35, 73728
  s_nop 0
  buffer_load_dwordx4 v10, s[8:11], s56 offen offset:0 sc1 lds
  buffer_load_dwordx4 v10, s[8:11], s56 offen offset:1024 sc1 lds
  s_add_u32 s56, s56, 4096
  s_waitcnt vmcnt(17)
  s_barrier
  s_add_u32 m0, s58, 153600
  s_nop 0
  buffer_load_dwordx4 v10, s[12:15], s57 offen offset:0 sc1 lds
  buffer_load_dwordx4 v10, s[12:15], s57 offen offset:1024 sc1 lds
  s_cbranch_vccnz Lsk_77
  buffer_load_dwordx4 v10, s[12:15], s57 offen offset:2048 sc1 lds
Lsk_77:
  s_add_u32 s57, s57, 81920
  s_add_u32 m0, s35, 32768
  s_nop 0
  buffer_load_dwordx4 v10, s[8:11], s56 offen offset:0 sc1 lds
  buffer_load_dwordx4 v10, s[8:11], s56 offen offset:1024 sc1 lds
  s_add_u32 s56, s56, 4096
  s_waitcnt vmcnt(10)
  s_barrier
  s_add_u32 m0, s58, 81920
  s_nop 0
  buffer_load_dwordx4 v10, s[12:15], s57 offen offset:0 sc1 lds
  buffer_load_dwordx4 v10, s[12:15], s57 offen offset:1024 sc1 lds
  s_cbranch_vccnz Lsk_78
  buffer_load_dwordx4 v10, s[12:15], s57 offen offset:2048 sc1 lds
Lsk_78:
  s_add_u32 s57, s57, 81920
  s_add_u32 m0, s35, 40960
  s_nop 0
  buffer_load_dwordx4 v10, s[8:11], s56 offen offset:0 sc1 lds
  buffer_load_dwordx4 v10, s[8:11], s56 offen offset:1024 sc1 lds
  s_add_u32 s56, s56, 4096
  s_waitcnt vmcnt(12)
  s_barrier
  s_add_u32 m0, s58, 92160
  s_nop 0
  buffer_load_dwordx4 v10, s[12:15], s57 offen offset:0 sc1 lds
  buffer_load_dwordx4 v10, s[12:15], s57 offen offset:1024 sc1 lds
  s_cbranch_vccnz Lsk_79
  buffer_load_dwordx4 v10, s[12:15], s57 offen offset:2048 sc1 lds
Lsk_79:
  s_add_u32 s57, s57, 81920
  s_add_u32 m0, s35, 49152
  s_nop 0
  buffer_load_dwordx4 v10, s[8:11], s56 offen offset:0 sc1 lds
  buffer_load_dwordx4 v10, s[8:11], s56 offen offset:1024 sc1 lds
  s_add_u32 s56, s56, 4096
  s_waitcnt vmcnt(14)
  s_barrier
  s_add_u32 m0, s58, 102400
  s_nop 0
  buffer_load_dwordx4 v10, s[12:15], s57 offen offset:0 sc1 lds
  buffer_load_dwordx4 v10, s[12:15], s57 offen offset:1024 sc1 lds
  s_cbranch_vccnz Lsk_80
  buffer_load_dwordx4 v10, s[12:15], s57 offen offset:2048 sc1 lds
Lsk_80:
  s_add_u32 s57, s57, 81920
  s_add_u32 m0, s35, 57344
  s_nop 0
  buffer_load_dwordx4 v10, s[8:11], s56 offen offset:0 sc1 lds
  buffer_load_dwordx4 v10, s[8:11], s56 offen offset:1024 sc1 lds
  s_add_u32 s56, s56, 4096
  s_waitcnt vmcnt(16)
  s_barrier
  s_add_u32 m0, s58, 112640
  s_nop 0
  buffer_load_dwordx4 v10, s[12:15], s57 offen offset:0 sc1 lds
  buffer_load_dwordx4 v10, s[12:15], s57 offen offset:1024 sc1 lds
  s_cbranch_vccnz Lsk_81
  buffer_load_dwordx4 v10, s[12:15], s57 offen offset:2048 sc1 lds
Lsk_81:
  s_add_u32 s57, s57, 81920
  s_add_u32 m0, s35, 65536
  s_nop 0
  buffer_load_dwordx4 v10, s[8:11], s56 offen offset:0 sc1 lds
  buffer_load_dwordx4 v10, s[8:11], s56 offen offset:1024 sc1 lds
  s_add_u32 s56, s56, 4096
  s_waitcnt vmcnt(16)
  s_barrier
  s_add_u32 m0, s58, 122880
  s_nop 0
  buffer_load_dwordx4 v10, s[12:15], s57 offen offset:0 sc1 lds
  buffer_load_dwordx4 v10, s[12:15], s57 offen offset:1024 sc1 lds
  s_cbranch_vccnz Lsk_82
  buffer_load_dwordx4 v10, s[12:15], s57 offen offset:2048 sc1 lds
Lsk_82:
  s_add_u32 s57, s57, 81920
  s_add_u32 m0, s35, 73728
  s_nop 0
  buffer_load_dwordx4 v10, s[8:11], s56 offen offset:0 sc1 lds
  buffer_load_dwordx4 v10, s[8:11], s56 offen offset:1024 sc1 lds
  s_add_u32 s56, s56, 4096
  s_waitcnt vmcnt(16)
  s_barrier
  s_add_u32 m0, s58, 133120
  s_nop 0
  buffer_load_dwordx4 v10, s[12:15], s57 offen offset:0 sc1 lds
  buffer_load_dwordx4 v10, s[12:15], s57 offen offset:1024 sc1 lds
  s_cbranch_vccnz Lsk_83
  buffer_load_dwordx4 v10, s[12:15], s57 offen offset:2048 sc1 lds
Lsk_83:
  s_add_u32 s57, s57, 81920
  s_add_u32 m0, s35, 32768
  s_nop 0
  buffer_load_dwordx4 v10, s[8:11], s56 offen offset:0 sc1 lds
  buffer_load_dwordx4 v10, s[8:11], s56 offen offset:1024 sc1 lds
  s_add_u32 s56, s56, 4096
  s_waitcnt vmcnt(16)
  s_barrier
  s_add_u32 m0, s58, 143360
  s_nop 0
  buffer_load_dwordx4 v10, s[12:15], s57 offen offset:0 sc1 lds
  buffer_load_dwordx4 v10, s[12:15], s57 offen offset:1024 sc1 lds
  s_cbranch_vccnz Lsk_84
  buffer_load_dwordx4 v10, s[12:15], s57 offen offset:2048 sc1 lds
Lsk_84:
  s_add_u32 s57, s57, 81920
  s_add_u32 m0, s35, 40960
  s_nop 0
  buffer_load_dwordx4 v10, s[8:11], s56 offen offset:0 sc1 lds
  buffer_load_dwordx4 v10, s[8:11], s56 offen offset:1024 sc1 lds
  s_add_u32 s56, s56, 4096
  s_waitcnt vmcnt(16)
  s_barrier
  s_add_u32 m0, s35, 49152
  s_nop 0
  buffer_load_dwordx4 v10, s[8:11], s56 offen offset:0 sc1 lds
  buffer_load_dwordx4 v10, s[8:11], s56 offen offset:1024 sc1 lds
  s_add_u32 s56, s56, 4096
  s_waitcnt vmcnt(14)
  s_barrier
  s_cmp_eq_u32 s27, 1
  s_cselect_b32 s56, 0x40000000, s56
  s_add_u32 m0, s35, 57344
  s_nop 0
  buffer_load_dwordx4 v10, s[8:11], s56 offen offset:0 sc1 lds
  buffer_load_dwordx4 v10, s[8:11], s56 offen offset:1024 sc1 lds
  s_add_u32 s56, s56, 4096
  s_waitcnt vmcnt(12)
  s_barrier
  s_waitcnt vmcnt(8)
  s_barrier
  s_waitcnt vmcnt(4)
  s_barrier
  s_waitcnt vmcnt(2)
  s_barrier
  s_waitcnt vmcnt(0)
  s_barrier
  s_endpgm
K2_consumer:
  s_barrier
  s_and_b32 s26, s26, 3
  s_lshl_b32 s42, s25, 2
  s_add_u32 s42, s42, s26
  s_and_b32 s64, s24, 3
  s_lshl_b32 s38, s26, 13
  s_add_u32 s38, s38, 0
  s_mov_b32 s31, 0
  s_mov_b32 s32, 124928
  s_mov_b32 s8, s50
  s_and_b32 s9, s51, 0xffff
  s_mov_b32 s10, 0x1000
  s_mov_b32 s11, 0x20000
  s_mov_b32 s20, s62
  s_and_b32 s21, s63, 0xffff
  s_mov_b32 s22, 0x280000
  s_mov_b32 s23, 0x20000
  v_lshrrev_b32 v1, 4, v0
  v_and_b32 v2, 15, v0
  v_and_b32 v3, 1, v1
  v_lshrrev_b32 v4, 1, v1
  v_lshl_add_u32 v5, v3, 5, v2
  v_lshlrev_b32 v5, 4, v5
  v_lshl_add_u32 v5, v4, 10, v5
  s_lshl_b32 s36, s27, 12
  v_add_u32 v8, s36, v5
  v_lshrrev_b32 v5, 2, v2
  v_lshl_add_u32 v5, v3, 2, v5
  v_lshl_add_u32 v5, v4, 4, v5
  v_mul_u32_u24 v5, 160, v5
  v_and_b32 v6, 3, v0
  v_lshl_add_u32 v5, v6, 3, v5
  s_mul_i32 s36, s28, 96
  v_add_u32 v9, s36, v5
  v_mul_u32_u24 v20, 160, v2
  v_lshl_add_u32 v20, v1, 3, v20
  s_lshl_b32 s36, s27, 13
  s_mul_i32 s37, s28, 96
  s_add_u32 s36, s36, s37
  v_add_u32 v20, s36, v20
  v_mul_u32_u24 v23, 1280, v2
  v_lshl_add_u32 v23, v1, 3, v23
  s_lshl_b32 s39, s24, 1
  s_add_u32 s39, s39, s27
  s_mul_i32 s60, s39, 40960
  s_mul_i32 s36, s25, 160
  s_add_u32 s60, s60, s36
  s_mul_i32 s36, s28, 96
  s_add_u32 s60, s60, s36
  s_add_u32 s61, s60, 20480
  s_lshl_b32 s37, s27, 5
  v_add_u32 v5, s37, v2
  v_lshlrev_b32 v11, 7, v5
  v_lshrrev_b32 v5, 1, v2
  v_xor_b32 v5, v5, v1
  v_lshl_add_u32 v11, v5, 4, v11
  s_and_b32 s37, s25, 1
  s_lshl_b32 s37, s37, 3
  v_bfe_u32 v5, v0, 2, 2
  v_lshl_add_u32 v5, v1, 3, v5
  v_and_b32 v6, 1, v0
  v_lshlrev_b32 v7, 2, v6
  v_xor_b32 v5, v5, v7
  v_xor_b32 v5, s37, v5
  v_lshl_add_u32 v5, v6, 5, v5
  v_lshlrev_b32 v5, 4, v5
  v_bfe_u32 v7, v0, 1, 1
  v_lshl_add_u32 v5, v7, 3, v5
  s_lshl_b32 s36, s28, 12
  v_add_u32 v12, s36, v5
  v_lshl_add_u32 v5, v3, 5, v2
  v_lshlrev_b32 v5, 4, v5
  v_lshl_add_u32 v30, v4, 3, v5
  v_lshlrev_b32 v5, 6, v3
  v_xor_b32 v21, v5, v30
  s_lshl_b32 s37, s37, 4
  v_xor_b32 v21, s37, v21
  v_xor_b32 v22, 0x80, v21
  v_lshlrev_b32 v31, 1, v2
  s_lshl_b32 s59, s24, 7
  s_add_u32 s59, s59, 0x1695000
  v_mov_b32 v224, 0
  v_mov_b32 v225, 0
  v_mov_b32 v226, 0
  v_mov_b32 v227, 0
  v_mov_b32 v228, 0
  v_mov_b32 v229, 0
  v_mov_b32 v230, 0
  v_mov_b32 v231, 0
  v_mov_b32 v232, 0
  v_mov_b32 v233, 0
  v_mov_b32 v234, 0
  v_mov_b32 v235, 0
  v_mov_b32 v236, 0
  v_mov_b32 v237, 0
  v_mov_b32 v238, 0
  v_mov_b32 v239, 0
  v_mov_b32 v240, 0
  v_mov_b32 v241, 0
  v_mov_b32 v242, 0
  v_mov_b32 v243, 0
  v_mov_b32 v244, 0
  v_mov_b32 v245, 0
  v_mov_b32 v246, 0
  v_mov_b32 v247, 0
  v_mov_b32 v248, 0
  v_mov_b32 v249, 0
  v_mov_b32 v250, 0
  v_mov_b32 v251, 0
  v_mov_b32 v252, 0
  v_mov_b32 v253, 0
  v_mov_b32 v254, 0
  v_mov_b32 v255, 0
  s_mul_i32 s36, s25, 7
  s_lshl_b32 s37, s28, 2
  s_add_u32 s45, s36, s37
  v_mov_b32 v80, 0
  v_mov_b32 v81, 0
  v_mov_b32 v82, 0
  v_mov_b32 v83, 0
  v_mov_b32 v84, 0
  v_mov_b32 v85, 0
  v_mov_b32 v86, 0
  v_mov_b32 v87, 0
  v_mov_b32 v88, 0
  v_mov_b32 v89, 0
  v_mov_b32 v90, 0
  v_mov_b32 v91, 0
  v_mov_b32 v92, 0
  v_mov_b32 v93, 0
  v_mov_b32 v94, 0
  v_mov_b32 v95, 0
  v_mov_b32 v96, 0
  v_mov_b32 v97, 0
  v_mov_b32 v98, 0
  v_mov_b32 v99, 0
  v_mov_b32 v100, 0
  v_mov_b32 v101, 0
  v_mov_b32 v102, 0
  v_mov_b32 v103, 0
  s_waitcnt vmcnt(0)
  s_barrier
  s_cmp_lg_u32 s26, 0
  s_cbranch_scc1 K2_noall
  v_mov_b32 v24, 1
  v_lshlrev_b32 v26, 7, v0
  s_mov_b64 exec, 0xff
  buffer_atomic_add v24, v26, s[16:19], s71 offen sc1
  s_cmp_eq_u32 s69, 1
  s_cbranch_scc1 K2_nolate
  s_sub_u32 s71, s71, 1024
  buffer_atomic_add v24, v26, s[16:19], s71 offen sc1
K2_nolate:
  s_mov_b64 exec, -1
K2_noall:
  s_barrier
  s_barrier
  s_cmp_eq_u32 s28, 1
  s_cbranch_scc1 K2_cc1
  v_add_u32 v13, s31, v11
  v_add_u32 v14, s32, v12
  v_xor_b32 v15, 64, v14
  ds_read_b128 v[128:131], v13 offset:0
  ds_read_b128 v[132:135], v13 offset:2048
  ds_read_b64_tr_b16 v[144:145], v14 offset:0
  ds_read_b64_tr_b16 v[146:147], v15 offset:0
  v_xor_b32 v17, 0x80, v14
  v_xor_b32 v18, 0xc0, v14
  ds_read_b64_tr_b16 v[148:149], v17 offset:1024
  ds_read_b64_tr_b16 v[150:151], v18 offset:1024
  ds_read_b64_tr_b16 v[152:153], v14 offset:2048
  ds_read_b64_tr_b16 v[154:155], v15 offset:2048
  ds_read_b64_tr_b16 v[156:157], v17 offset:3072
  ds_read_b64_tr_b16 v[158:159], v18 offset:3072
  v_xor_b32 v16, 64, v13
  ds_read_b128 v[136:139], v16 offset:0
  ds_read_b128 v[140:143], v16 offset:2048
  ds_read_b64_tr_b16 v[160:161], v14 offset:7168
  ds_read_b64_tr_b16 v[162:163], v15 offset:7168
  ds_read_b64_tr_b16 v[164:165], v17 offset:8192
  ds_read_b64_tr_b16 v[166:167], v18 offset:8192
  ds_read_b64_tr_b16 v[168:169], v14 offset:9216
  ds_read_b64_tr_b16 v[170:171], v15 offset:9216
  ds_read_b64_tr_b16 v[172:173], v17 offset:10240
  ds_read_b64_tr_b16 v[174:175], v18 offset:10240
  s_add_u32 s31, s31, 8192
  s_cmp_eq_u32 s31, 81920
  s_cselect_b32 s31, 32768, s31
  s_add_u32 s32, s32, 14336
  s_cmp_eq_u32 s32, 153600
  s_cselect_b32 s32, 81920, s32
  s_mov_b32 s33, 0
  s_lshl_b32 s36, s39, 6
  buffer_load_ushort v19, v31, s[8:11], s36 offen
  buffer_load_ushort v31, v31, s[8:11], s36 offen offset:32
K2_loop_0:
  s_waitcnt lgkmcnt(0)
  s_barrier
  v_mfma_f32_16x16x32_bf16 v[224:227], v[144:147], v[128:131], v[224:227]
  v_add_u32 v13, s31, v11
  v_add_u32 v14, s32, v12
  v_xor_b32 v15, 64, v14
  v_mfma_f32_16x16x32_bf16 v[240:243], v[144:147], v[132:135], v[240:243]
  ds_read_b128 v[176:179], v13 offset:0
  ds_read_b128 v[180:183], v13 offset:2048
  ds_read_b64_tr_b16 v[192:193], v14 offset:0
  v_mfma_f32_16x16x32_bf16 v[228:231], v[148:151], v[128:131], v[228:231]
  ds_read_b64_tr_b16 v[194:195], v15 offset:0
  v_xor_b32 v17, 0x80, v14
  v_xor_b32 v18, 0xc0, v14
  v_mfma_f32_16x16x32_bf16 v[244:247], v[148:151], v[132:135], v[244:247]
  ds_read_b64_tr_b16 v[196:197], v17 offset:1024
  ds_read_b64_tr_b16 v[198:199], v18 offset:1024
  ds_read_b64_tr_b16 v[200:201], v14 offset:2048
  v_mfma_f32_16x16x32_bf16 v[232:235], v[152:155], v[128:131], v[232:235]
  ds_read_b64_tr_b16 v[202:203], v15 offset:2048
  ds_read_b64_tr_b16 v[204:205], v17 offset:3072
  ds_read_b64_tr_b16 v[206:207], v18 offset:3072
  v_mfma_f32_16x16x32_bf16 v[248:251], v[152:155], v[132:135], v[248:251]
  v_xor_b32 v16, 64, v13
  ds_read_b128 v[184:187], v16 offset:0
  ds_read_b128 v[188:191], v16 offset:2048
  v_mfma_f32_16x16x32_bf16 v[236:239], v[156:159], v[128:131], v[236:239]
  ds_read_b64_tr_b16 v[208:209], v14 offset:7168
  ds_read_b64_tr_b16 v[210:211], v15 offset:7168
  v_mfma_f32_16x16x32_bf16 v[252:255], v[156:159], v[132:135], v[252:255]
  ds_read_b64_tr_b16 v[212:213], v17 offset:8192
  ds_read_b64_tr_b16 v[214:215], v18 offset:8192
  v_mfma_f32_16x16x32_bf16 v[224:227], v[160:163], v[136:139], v[224:227]
  ds_read_b64_tr_b16 v[216:217], v14 offset:9216
  ds_read_b64_tr_b16 v[218:219], v15 offset:9216
  v_mfma_f32_16x16x32_bf16 v[240:243], v[160:163], v[140:143], v[240:243]
  ds_read_b64_tr_b16 v[220:221], v17 offset:10240
  ds_read_b64_tr_b16 v[222:223], v18 offset:10240
  v_mfma_f32_16x16x32_bf16 v[228:231], v[164:167], v[136:139], v[228:231]
  s_add_u32 s31, s31, 8192
  s_cmp_eq_u32 s31, 81920
  s_cselect_b32 s31, 32768, s31
  s_add_u32 s32, s32, 14336
  s_cmp_eq_u32 s32, 153600
  s_cselect_b32 s32, 81920, s32
  v_mfma_f32_16x16x32_bf16 v[244:247], v[164:167], v[140:143], v[244:247]
  v_mfma_f32_16x16x32_bf16 v[232:235], v[168:171], v[136:139], v[232:235]
  v_mfma_f32_16x16x32_bf16 v[248:251], v[168:171], v[140:143], v[248:251]
  v_mfma_f32_16x16x32_bf16 v[236:239], v[172:175], v[136:139], v[236:239]
  v_mfma_f32_16x16x32_bf16 v[252:255], v[172:175], v[140:143], v[252:255]
  s_waitcnt lgkmcnt(0)
  s_barrier
  v_mfma_f32_16x16x32_bf16 v[224:227], v[192:195], v[176:179], v[224:227]
  v_add_u32 v13, s31, v11
  v_add_u32 v14, s32, v12
  v_xor_b32 v15, 64, v14
  v_mfma_f32_16x16x32_bf16 v[240:243], v[192:195], v[180:183], v[240:243]
  ds_read_b128 v[128:131], v13 offset:0
  ds_read_b128 v[132:135], v13 offset:2048
  ds_read_b64_tr_b16 v[144:145], v14 offset:0
  v_mfma_f32_16x16x32_bf16 v[228:231], v[196:199], v[176:179], v[228:231]
  ds_read_b64_tr_b16 v[146:147], v15 offset:0
  v_xor_b32 v17, 0x80, v14
  v_xor_b32 v18, 0xc0, v14
  v_mfma_f32_16x16x32_bf16 v[244:247], v[196:199], v[180:183], v[244:247]
  ds_read_b64_tr_b16 v[148:149], v17 offset:1024
  ds_read_b64_tr_b16 v[150:151], v18 offset:1024
  ds_read_b64_tr_b16 v[152:153], v14 offset:2048
  v_mfma_f32_16x16x32_bf16 v[232:235], v[200:203], v[176:179], v[232:235]
  ds_read_b64_tr_b16 v[154:155], v15 offset:2048
  ds_read_b64_tr_b16 v[156:157], v17 offset:3072
  ds_read_b64_tr_b16 v[158:159], v18 offset:3072
  v_mfma_f32_16x16x32_bf16 v[248:251], v[200:203], v[180:183], v[248:251]
  v_xor_b32 v16, 64, v13
  ds_read_b128 v[136:139], v16 offset:0
  ds_read_b128 v[140:143], v16 offset:2048
  v_mfma_f32_16x16x32_bf16 v[236:239], v[204:207], v[176:179], v[236:239]
  ds_read_b64_tr_b16 v[160:161], v14 offset:7168
  ds_read_b64_tr_b16 v[162:163], v15 offset:7168
  v_mfma_f32_16x16x32_bf16 v[252:255], v[204:207], v[180:183], v[252:255]
  ds_read_b64_tr_b16 v[164:165], v17 offset:8192
  ds_read_b64_tr_b16 v[166:167], v18 offset:8192
  v_mfma_f32_16x16x32_bf16 v[224:227], v[208:211], v[184:187], v[224:227]
  ds_read_b64_tr_b16 v[168:169], v14 offset:9216
  ds_read_b64_tr_b16 v[170:171], v15 offset:9216
  v_mfma_f32_16x16x32_bf16 v[240:243], v[208:211], v[188:191], v[240:243]
  ds_read_b64_tr_b16 v[172:173], v17 offset:10240
  ds_read_b64_tr_b16 v[174:175], v18 offset:10240
  v_mfma_f32_16x16x32_bf16 v[228:231], v[212:215], v[184:187], v[228:231]
  s_add_u32 s31, s31, 8192
  s_cmp_eq_u32 s31, 81920
  s_cselect_b32 s31, 32768, s31
  s_add_u32 s32, s32, 14336
  s_cmp_eq_u32 s32, 153600
  s_cselect_b32 s32, 81920, s32
  v_mfma_f32_16x16x32_bf16 v[244:247], v[212:215], v[188:191], v[244:247]
  v_mfma_f32_16x16x32_bf16 v[232:235], v[216:219], v[184:187], v[232:235]
  v_mfma_f32_16x16x32_bf16 v[248:251], v[216:219], v[188:191], v[248:251]
  v_mfma_f32_16x16x32_bf16 v[236:239], v[220:223], v[184:187], v[236:239]
  v_mfma_f32_16x16x32_bf16 v[252:255], v[220:223], v[188:191], v[252:255]
  s_add_u32 s33, s33, 1
  s_cmp_eq_u32 s33, 15
  s_cbranch_scc0 K2_loop_0
  s_waitcnt lgkmcnt(0)
  s_barrier
  v_mfma_f32_16x16x32_bf16 v[224:227], v[144:147], v[128:131], v[224:227]
  v_add_u32 v13, s31, v11
  v_add_u32 v14, s32, v12
  v_xor_b32 v15, 64, v14
  ds_read_b128 v[176:179], v13 offset:0
  v_mfma_f32_16x16x32_bf16 v[240:243], v[144:147], v[132:135], v[240:243]
  ds_read_b128 v[180:183], v13 offset:2048
  ds_read_b64_tr_b16 v[192:193], v14 offset:0
  ds_read_b64_tr_b16 v[194:195], v15 offset:0
  v_mfma_f32_16x16x32_bf16 v[228:231], v[148:151], v[128:131], v[228:231]
  v_xor_b32 v17, 0x80, v14
  v_xor_b32 v18, 0xc0, v14
  ds_read_b64_tr_b16 v[196:197], v17 offset:1024
  v_mfma_f32_16x16x32_bf16 v[244:247], v[148:151], v[132:135], v[244:247]
  ds_read_b64_tr_b16 v[198:199], v18 offset:1024
  ds_read_b64_tr_b16 v[200:201], v14 offset:2048
  ds_read_b64_tr_b16 v[202:203], v15 offset:2048
  v_mfma_f32_16x16x32_bf16 v[232:235], v[152:155], v[128:131], v[232:235]
  ds_read_b64_tr_b16 v[204:205], v17 offset:3072
  ds_read_b64_tr_b16 v[206:207], v18 offset:3072
  v_xor_b32 v16, 64, v13
  v_mfma_f32_16x16x32_bf16 v[248:251], v[152:155], v[132:135], v[248:251]
  ds_read_b128 v[184:187], v16 offset:0
  ds_read_b128 v[188:191], v16 offset:2048
  ds_read_b64_tr_b16 v[208:209], v14 offset:7168
  v_mfma_f32_16x16x32_bf16 v[236:239], v[156:159], v[128:131], v[236:239]
  ds_read_b64_tr_b16 v[210:211], v15 offset:7168
  ds_read_b64_tr_b16 v[212:213], v17 offset:8192
  ds_read_b64_tr_b16 v[214:215], v18 offset:8192
  v_mfma_f32_16x16x32_bf16 v[252:255], v[156:159], v[132:135], v[252:255]
  ds_read_b64_tr_b16 v[216:217], v14 offset:9216
  ds_read_b64_tr_b16 v[218:219], v15 offset:9216
  ds_read_b64_tr_b16 v[220:221], v17 offset:10240
  v_mfma_f32_16x16x32_bf16 v[224:227], v[160:163], v[136:139], v[224:227]
  ds_read_b64_tr_b16 v[222:223], v18 offset:10240
  s_add_u32 s31, s31, 8192
  s_cmp_eq_u32 s31, 81920
  s_cselect_b32 s31, 32768, s31
  s_add_u32 s32, s32, 14336
  s_cmp_eq_u32 s32, 153600
  s_cselect_b32 s32, 81920, s32
  v_mfma_f32_16x16x32_bf16 v[240:243], v[160:163], v[140:143], v[240:243]
  ds_read_b64 v[36:37], v20 offset:0
  ds_read_b64 v[38:39], v20 offset:32
  ds_read_b64 v[40:41], v20 offset:64
  v_mfma_f32_16x16x32_bf16 v[228:231], v[164:167], v[136:139], v[228:231]
  ds_read_b64 v[42:43], v20 offset:4096
  ds_read_b64 v[44:45], v20 offset:4128
  ds_read_b64 v[46:47], v20 offset:4160
  v_mfma_f32_16x16x32_bf16 v[244:247], v[164:167], v[140:143], v[244:247]
  v_mfma_f32_16x16x32_bf16 v[232:235], v[168:171], v[136:139], v[232:235]
  v_mfma_f32_16x16x32_bf16 v[248:251], v[168:171], v[140:143], v[248:251]
  v_mfma_f32_16x16x32_bf16 v[236:239], v[172:175], v[136:139], v[236:239]
  v_mfma_f32_16x16x32_bf16 v[252:255], v[172:175], v[140:143], v[252:255]
  s_waitcnt lgkmcnt(0)
  s_barrier
  v_mfma_f32_16x16x32_bf16 v[224:227], v[192:195], v[176:179], v[224:227]
  s_mul_i32 s36, s27, 7168
  v_add_u32 v21, s36, v21
  v_add_u32 v22, s36, v22
  v_mfma_f32_16x16x32_bf16 v[240:243], v[192:195], v[180:183], v[240:243]
  ds_read_b64 v[112:113], v21 offset:16384
  ds_read_b64 v[120:121], v21 offset:16640
  ds_read_b64 v[114:115], v22 offset:17408
  v_mfma_f32_16x16x32_bf16 v[228:231], v[196:199], v[176:179], v[228:231]
  ds_read_b64 v[122:123], v22 offset:17664
  ds_read_b64 v[116:117], v21 offset:18432
  ds_read_b64 v[124:125], v21 offset:18688
  v_mfma_f32_16x16x32_bf16 v[244:247], v[196:199], v[180:183], v[244:247]
  ds_read_b64 v[118:119], v22 offset:19456
  ds_read_b64 v[126:127], v22 offset:19712
  v_mfma_f32_16x16x32_bf16 v[232:235], v[200:203], v[176:179], v[232:235]
  v_lshlrev_b32 v80, 16, v36
  v_and_b32 v81, 0xffff0000, v36
  v_mfma_f32_16x16x32_bf16 v[248:251], v[200:203], v[180:183], v[248:251]
  v_lshlrev_b32 v82, 16, v37
  v_and_b32 v83, 0xffff0000, v37
  v_mfma_f32_16x16x32_bf16 v[236:239], v[204:207], v[176:179], v[236:239]
  v_lshlrev_b32 v84, 16, v38
  v_and_b32 v85, 0xffff0000, v38
  v_mfma_f32_16x16x32_bf16 v[252:255], v[204:207], v[180:183], v[252:255]
  v_lshlrev_b32 v86, 16, v39
  v_and_b32 v87, 0xffff0000, v39
  v_mfma_f32_16x16x32_bf16 v[224:227], v[208:211], v[184:187], v[224:227]
  v_lshlrev_b32 v88, 16, v40
  v_and_b32 v89, 0xffff0000, v40
  v_mfma_f32_16x16x32_bf16 v[240:243], v[208:211], v[188:191], v[240:243]
  v_lshlrev_b32 v90, 16, v41
  v_and_b32 v91, 0xffff0000, v41
  v_mfma_f32_16x16x32_bf16 v[228:231], v[212:215], v[184:187], v[228:231]
  v_lshlrev_b32 v92, 16, v42
  v_and_b32 v93, 0xffff0000, v42
  v_mfma_f32_16x16x32_bf16 v[244:247], v[212:215], v[188:191], v[244:247]
  v_lshlrev_b32 v94, 16, v43
  v_and_b32 v95, 0xffff0000, v43
  v_mfma_f32_16x16x32_bf16 v[232:235], v[216:219], v[184:187], v[232:235]
  v_lshlrev_b32 v96, 16, v44
  v_and_b32 v97, 0xffff0000, v44
  v_mfma_f32_16x16x32_bf16 v[248:251], v[216:219], v[188:191], v[248:251]
  v_lshlrev_b32 v98, 16, v45
  v_and_b32 v99, 0xffff0000, v45
  v_mfma_f32_16x16x32_bf16 v[236:239], v[220:223], v[184:187], v[236:239]
  v_lshlrev_b32 v100, 16, v46
  v_and_b32 v101, 0xffff0000, v46
  v_mfma_f32_16x16x32_bf16 v[252:255], v[220:223], v[188:191], v[252:255]
  v_lshlrev_b32 v102, 16, v47
  v_and_b32 v103, 0xffff0000, v47
  s_waitcnt lgkmcnt(0)
  s_mov_b32 s32, 153600
  s_waitcnt vmcnt(0)
  v_lshlrev_b32 v19, 16, v19
  s_mul_i32 s36, s39, 94
  s_add_u32 s36, s36, s45
  s_lshl_b32 s36, s36, 10
  s_add_u32 s36, s36, 15245312
  v_lshlrev_b32 v31, 16, v31
  v_lshlrev_b32 v24, 16, v112
  v_and_b32 v25, 0xffff0000, v112
  v_add_f32 v224, v224, v19
  v_add_f32 v225, v225, v19
  v_mul_f32 v24, v24, v224
  v_mul_f32 v25, v25, v225
  v_cvt_pk_bf16_f32 v112, v24, v25
  v_lshlrev_b32 v26, 16, v113
  v_and_b32 v27, 0xffff0000, v113
  v_add_f32 v226, v226, v19
  v_add_f32 v227, v227, v19
  v_mul_f32 v26, v26, v226
  v_mul_f32 v27, v27, v227
  v_cvt_pk_bf16_f32 v113, v26, v27
  buffer_store_dwordx2 v[112:113], v30, s[16:19], s36 offen offset:0 sc1
  v_lshlrev_b32 v24, 16, v120
  v_and_b32 v25, 0xffff0000, v120
  v_add_f32 v240, v240, v31
  v_add_f32 v241, v241, v31
  v_mul_f32 v24, v24, v240
  v_mul_f32 v25, v25, v241
  v_cvt_pk_bf16_f32 v120, v24, v25
  v_lshlrev_b32 v26, 16, v121
  v_and_b32 v27, 0xffff0000, v121
  v_add_f32 v242, v242, v31
  v_add_f32 v243, v243, v31
  v_mul_f32 v26, v26, v242
  v_mul_f32 v27, v27, v243
  v_cvt_pk_bf16_f32 v121, v26, v27
  buffer_store_dwordx2 v[120:121], v30, s[16:19], s36 offen offset:256 sc1
  v_lshlrev_b32 v24, 16, v114
  v_and_b32 v25, 0xffff0000, v114
  v_add_f32 v228, v228, v19
  v_add_f32 v229, v229, v19
  v_mul_f32 v24, v24, v228
  v_mul_f32 v25, v25, v229
  v_cvt_pk_bf16_f32 v114, v24, v25
  v_lshlrev_b32 v26, 16, v115
  v_and_b32 v27, 0xffff0000, v115
  v_add_f32 v230, v230, v19
  v_add_f32 v231, v231, v19
  v_mul_f32 v26, v26, v230
  v_mul_f32 v27, v27, v231
  v_cvt_pk_bf16_f32 v115, v26, v27
  buffer_store_dwordx2 v[114:115], v30, s[16:19], s36 offen offset:1024 sc1
  v_lshlrev_b32 v24, 16, v122
  v_and_b32 v25, 0xffff0000, v122
  v_add_f32 v244, v244, v31
  v_add_f32 v245, v245, v31
  v_mul_f32 v24, v24, v244
  v_mul_f32 v25, v25, v245
  v_cvt_pk_bf16_f32 v122, v24, v25
  v_lshlrev_b32 v26, 16, v123
  v_and_b32 v27, 0xffff0000, v123
  v_add_f32 v246, v246, v31
  v_add_f32 v247, v247, v31
  v_mul_f32 v26, v26, v246
  v_mul_f32 v27, v27, v247
  v_cvt_pk_bf16_f32 v123, v26, v27
  buffer_store_dwordx2 v[122:123], v30, s[16:19], s36 offen offset:1280 sc1
  v_lshlrev_b32 v24, 16, v116
  v_and_b32 v25, 0xffff0000, v116
  v_add_f32 v232, v232, v19
  v_add_f32 v233, v233, v19
  v_mul_f32 v24, v24, v232
  v_mul_f32 v25, v25, v233
  v_cvt_pk_bf16_f32 v116, v24, v25
  v_lshlrev_b32 v26, 16, v117
  v_and_b32 v27, 0xffff0000, v117
  v_add_f32 v234, v234, v19
  v_add_f32 v235, v235, v19
  v_mul_f32 v26, v26, v234
  v_mul_f32 v27, v27, v235
  v_cvt_pk_bf16_f32 v117, v26, v27
  buffer_store_dwordx2 v[116:117], v30, s[16:19], s36 offen offset:2048 sc1
  v_lshlrev_b32 v24, 16, v124
  v_and_b32 v25, 0xffff0000, v124
  v_add_f32 v248, v248, v31
  v_add_f32 v249, v249, v31
  v_mul_f32 v24, v24, v248
  v_mul_f32 v25, v25, v249
  v_cvt_pk_bf16_f32 v124, v24, v25
  v_lshlrev_b32 v26, 16, v125
  v_and_b32 v27, 0xffff0000, v125
  v_add_f32 v250, v250, v31
  v_add_f32 v251, v251, v31
  v_mul_f32 v26, v26, v250
  v_mul_f32 v27, v27, v251
  v_cvt_pk_bf16_f32 v125, v26, v27
  buffer_store_dwordx2 v[124:125], v30, s[16:19], s36 offen offset:2304 sc1
  v_lshlrev_b32 v24, 16, v118
  v_and_b32 v25, 0xffff0000, v118
  v_add_f32 v236, v236, v19
  v_add_f32 v237, v237, v19
  v_mul_f32 v24, v24, v236
  v_mul_f32 v25, v25, v237
  v_cvt_pk_bf16_f32 v118, v24, v25
  v_lshlrev_b32 v26, 16, v119
  v_and_b32 v27, 0xffff0000, v119
  v_add_f32 v238, v238, v19
  v_add_f32 v239, v239, v19
  v_mul_f32 v26, v26, v238
  v_mul_f32 v27, v27, v239
  v_cvt_pk_bf16_f32 v119, v26, v27
  buffer_store_dwordx2 v[118:119], v30, s[16:19], s36 offen offset:3072 sc1
  v_lshlrev_b32 v24, 16, v126
  v_and_b32 v25, 0xffff0000, v126
  v_add_f32 v252, v252, v31
  v_add_f32 v253, v253, v31
  v_mul_f32 v24, v24, v252
  v_mul_f32 v25, v25, v253
  v_cvt_pk_bf16_f32 v126, v24, v25
  v_lshlrev_b32 v26, 16, v127
  v_and_b32 v27, 0xffff0000, v127
  v_add_f32 v254, v254, v31
  v_add_f32 v255, v255, v31
  v_mul_f32 v26, v26, v254
  v_mul_f32 v27, v27, v255
  v_cvt_pk_bf16_f32 v127, v26, v27
  buffer_store_dwordx2 v[126:127], v30, s[16:19], s36 offen offset:3328 sc1
K2_done_0:
  s_add_u32 s59, s59, 4096
  s_barrier
  v_add_u32 v13, s31, v8
  v_add_u32 v14, s32, v9
  ds_read_b128 v[128:131], v13 offset:0
  ds_read_b128 v[132:135], v13 offset:256
  ds_read_b64_tr_b16 v[144:145], v14 offset:0
  ds_read_b64_tr_b16 v[146:147], v14 offset:1280
  ds_read_b64_tr_b16 v[148:149], v14 offset:32
  ds_read_b64_tr_b16 v[150:151], v14 offset:1312
  ds_read_b64_tr_b16 v[152:153], v14 offset:64
  ds_read_b64_tr_b16 v[154:155], v14 offset:1344
  ds_read_b128 v[136:139], v13 offset:2048
  ds_read_b128 v[140:143], v13 offset:2304
  ds_read_b64_tr_b16 v[156:157], v14 offset:5120
  ds_read_b64_tr_b16 v[158:159], v14 offset:6400
  ds_read_b64_tr_b16 v[160:161], v14 offset:5152
  ds_read_b64_tr_b16 v[162:163], v14 offset:6432
  ds_read_b64_tr_b16 v[164:165], v14 offset:5184
  ds_read_b64_tr_b16 v[166:167], v14 offset:6464
  s_add_u32 s31, s31, 8192
  s_cmp_eq_u32 s31, 81920
  s_cselect_b32 s31, 32768, s31
  s_add_u32 s32, s32, 10240
  s_cmp_eq_u32 s32, 163840
  s_cselect_b32 s32, 81920, s32
  s_waitcnt lgkmcnt(0)
  s_barrier
  v_mfma_f32_16x16x32_bf16 v[80:83], v[144:147], v[128:131], v[80:83]
  v_add_u32 v13, s31, v8
  v_add_u32 v14, s32, v9
  ds_read_b128 v[176:179], v13 offset:0
  v_mfma_f32_16x16x32_bf16 v[92:95], v[144:147], v[132:135], v[92:95]
  ds_read_b128 v[180:183], v13 offset:256
  ds_read_b64_tr_b16 v[192:193], v14 offset:0
  ds_read_b64_tr_b16 v[194:195], v14 offset:1280
  v_mfma_f32_16x16x32_bf16 v[84:87], v[148:151], v[128:131], v[84:87]
  ds_read_b64_tr_b16 v[196:197], v14 offset:32
  ds_read_b64_tr_b16 v[198:199], v14 offset:1312
  ds_read_b64_tr_b16 v[200:201], v14 offset:64
  v_mfma_f32_16x16x32_bf16 v[96:99], v[148:151], v[132:135], v[96:99]
  ds_read_b64_tr_b16 v[202:203], v14 offset:1344
  ds_read_b128 v[184:187], v13 offset:2048
  ds_read_b128 v[188:191], v13 offset:2304
  v_mfma_f32_16x16x32_bf16 v[88:91], v[152:155], v[128:131], v[88:91]
  ds_read_b64_tr_b16 v[204:205], v14 offset:5120
  ds_read_b64_tr_b16 v[206:207], v14 offset:6400
  v_mfma_f32_16x16x32_bf16 v[100:103], v[152:155], v[132:135], v[100:103]
  ds_read_b64_tr_b16 v[208:209], v14 offset:5152
  ds_read_b64_tr_b16 v[210:211], v14 offset:6432
  v_mfma_f32_16x16x32_bf16 v[80:83], v[156:159], v[136:139], v[80:83]
  ds_read_b64_tr_b16 v[212:213], v14 offset:5184
  ds_read_b64_tr_b16 v[214:215], v14 offset:6464
  v_mfma_f32_16x16x32_bf16 v[92:95], v[156:159], v[140:143], v[92:95]
  s_add_u32 s31, s31, 8192
  s_cmp_eq_u32 s31, 81920
  s_cselect_b32 s31, 32768, s31
  s_add_u32 s32, s32, 10240
  s_cmp_eq_u32 s32, 163840
  s_cselect_b32 s32, 81920, s32
  v_mfma_f32_16x16x32_bf16 v[84:87], v[160:163], v[136:139], v[84:87]
  v_mfma_f32_16x16x32_bf16 v[96:99], v[160:163], v[140:143], v[96:99]
  v_mfma_f32_16x16x32_bf16 v[88:91], v[164:167], v[136:139], v[88:91]
  v_mfma_f32_16x16x32_bf16 v[100:103], v[164:167], v[140:143], v[100:103]
  s_waitcnt lgkmcnt(0)
  s_barrier
  v_mfma_f32_16x16x32_bf16 v[80:83], v[192:195], v[176:179], v[80:83]
  v_add_u32 v13, s31, v8
  v_add_u32 v14, s32, v9
  ds_read_b128 v[128:131], v13 offset:0
  v_mfma_f32_16x16x32_bf16 v[92:95], v[192:195], v[180:183], v[92:95]
  ds_read_b128 v[132:135], v13 offset:256
  ds_read_b64_tr_b16 v[144:145], v14 offset:0
  ds_read_b64_tr_b16 v[146:147], v14 offset:1280
  v_mfma_f32_16x16x32_bf16 v[84:87], v[196:199], v[176:179], v[84:87]
  ds_read_b64_tr_b16 v[148:149], v14 offset:32
  ds_read_b64_tr_b16 v[150:151], v14 offset:1312
  ds_read_b64_tr_b16 v[152:153], v14 offset:64
  v_mfma_f32_16x16x32_bf16 v[96:99], v[196:199], v[180:183], v[96:99]
  ds_read_b64_tr_b16 v[154:155], v14 offset:1344
  ds_read_b128 v[136:139], v13 offset:2048
  ds_read_b128 v[140:143], v13 offset:2304
  v_mfma_f32_16x16x32_bf16 v[88:91], v[200:203], v[176:179], v[88:91]
  ds_read_b64_tr_b16 v[156:157], v14 offset:5120
  ds_read_b64_tr_b16 v[158:159], v14 offset:6400
  v_mfma_f32_16x16x32_bf16 v[100:103], v[200:203], v[180:183], v[100:103]
  ds_read_b64_tr_b16 v[160:161], v14 offset:5152
  ds_read_b64_tr_b16 v[162:163], v14 offset:6432
  v_mfma_f32_16x16x32_bf16 v[80:83], v[204:207], v[184:187], v[80:83]
  ds_read_b64_tr_b16 v[164:165], v14 offset:5184
  ds_read_b64_tr_b16 v[166:167], v14 offset:6464
  v_mfma_f32_16x16x32_bf16 v[92:95], v[204:207], v[188:191], v[92:95]
  s_add_u32 s31, s31, 8192
  s_cmp_eq_u32 s31, 81920
  s_cselect_b32 s31, 32768, s31
  s_add_u32 s32, s32, 10240
  s_cmp_eq_u32 s32, 163840
  s_cselect_b32 s32, 81920, s32
  v_mfma_f32_16x16x32_bf16 v[84:87], v[208:211], v[184:187], v[84:87]
  v_mfma_f32_16x16x32_bf16 v[96:99], v[208:211], v[188:191], v[96:99]
  v_mfma_f32_16x16x32_bf16 v[88:91], v[212:215], v[184:187], v[88:91]
  v_mfma_f32_16x16x32_bf16 v[100:103], v[212:215], v[188:191], v[100:103]
  s_waitcnt vmcnt(0)
  v_mov_b32 v24, 1
  v_mov_b32 v25, 0
  s_mov_b64 exec, 1
  buffer_atomic_add v24, v25, s[16:19], s59 offen offset:0 sc1
  s_mov_b64 exec, -1
  s_mov_b32 s33, 1
K3_loop_0:
  s_waitcnt lgkmcnt(0)
  s_barrier
  v_mfma_f32_16x16x32_bf16 v[80:83], v[144:147], v[128:131], v[80:83]
  v_add_u32 v13, s31, v8
  v_add_u32 v14, s32, v9
  ds_read_b128 v[176:179], v13 offset:0
  v_mfma_f32_16x16x32_bf16 v[92:95], v[144:147], v[132:135], v[92:95]
  ds_read_b128 v[180:183], v13 offset:256
  ds_read_b64_tr_b16 v[192:193], v14 offset:0
  ds_read_b64_tr_b16 v[194:195], v14 offset:1280
  v_mfma_f32_16x16x32_bf16 v[84:87], v[148:151], v[128:131], v[84:87]
  ds_read_b64_tr_b16 v[196:197], v14 offset:32
  ds_read_b64_tr_b16 v[198:199], v14 offset:1312
  ds_read_b64_tr_b16 v[200:201], v14 offset:64
  v_mfma_f32_16x16x32_bf16 v[96:99], v[148:151], v[132:135], v[96:99]
  ds_read_b64_tr_b16 v[202:203], v14 offset:1344
  ds_read_b128 v[184:187], v13 offset:2048
  ds_read_b128 v[188:191], v13 offset:2304
  v_mfma_f32_16x16x32_bf16 v[88:91], v[152:155], v[128:131], v[88:91]
  ds_read_b64_tr_b16 v[204:205], v14 offset:5120
  ds_read_b64_tr_b16 v[206:207], v14 offset:6400
  v_mfma_f32_16x16x32_bf16 v[100:103], v[152:155], v[132:135], v[100:103]
  ds_read_b64_tr_b16 v[208:209], v14 offset:5152
  ds_read_b64_tr_b16 v[210:211], v14 offset:6432
  v_mfma_f32_16x16x32_bf16 v[80:83], v[156:159], v[136:139], v[80:83]
  ds_read_b64_tr_b16 v[212:213], v14 offset:5184
  ds_read_b64_tr_b16 v[214:215], v14 offset:6464
  v_mfma_f32_16x16x32_bf16 v[92:95], v[156:159], v[140:143], v[92:95]
  s_add_u32 s31, s31, 8192
  s_cmp_eq_u32 s31, 81920
  s_cselect_b32 s31, 32768, s31
  s_add_u32 s32, s32, 10240
  s_cmp_eq_u32 s32, 163840
  s_cselect_b32 s32, 81920, s32
  v_mfma_f32_16x16x32_bf16 v[84:87], v[160:163], v[136:139], v[84:87]
  v_mfma_f32_16x16x32_bf16 v[96:99], v[160:163], v[140:143], v[96:99]
  v_mfma_f32_16x16x32_bf16 v[88:91], v[164:167], v[136:139], v[88:91]
  v_mfma_f32_16x16x32_bf16 v[100:103], v[164:167], v[140:143], v[100:103]
  s_waitcnt lgkmcnt(0)
  s_barrier
  v_mfma_f32_16x16x32_bf16 v[80:83], v[192:195], v[176:179], v[80:83]
  v_add_u32 v13, s31, v8
  v_add_u32 v14, s32, v9
  ds_read_b128 v[128:131], v13 offset:0
  v_mfma_f32_16x16x32_bf16 v[92:95], v[192:195], v[180:183], v[92:95]
  ds_read_b128 v[132:135], v13 offset:256
  ds_read_b64_tr_b16 v[144:145], v14 offset:0
  ds_read_b64_tr_b16 v[146:147], v14 offset:1280
  v_mfma_f32_16x16x32_bf16 v[84:87], v[196:199], v[176:179], v[84:87]
  ds_read_b64_tr_b16 v[148:149], v14 offset:32
  ds_read_b64_tr_b16 v[150:151], v14 offset:1312
  ds_read_b64_tr_b16 v[152:153], v14 offset:64
  v_mfma_f32_16x16x32_bf16 v[96:99], v[196:199], v[180:183], v[96:99]
  ds_read_b64_tr_b16 v[154:155], v14 offset:1344
  ds_read_b128 v[136:139], v13 offset:2048
  ds_read_b128 v[140:143], v13 offset:2304
  v_mfma_f32_16x16x32_bf16 v[88:91], v[200:203], v[176:179], v[88:91]
  ds_read_b64_tr_b16 v[156:157], v14 offset:5120
  ds_read_b64_tr_b16 v[158:159], v14 offset:6400
  v_mfma_f32_16x16x32_bf16 v[100:103], v[200:203], v[180:183], v[100:103]
  ds_read_b64_tr_b16 v[160:161], v14 offset:5152
  ds_read_b64_tr_b16 v[162:163], v14 offset:6432
  v_mfma_f32_16x16x32_bf16 v[80:83], v[204:207], v[184:187], v[80:83]
  ds_read_b64_tr_b16 v[164:165], v14 offset:5184
  ds_read_b64_tr_b16 v[166:167], v14 offset:6464
  v_mfma_f32_16x16x32_bf16 v[92:95], v[204:207], v[188:191], v[92:95]
  s_add_u32 s31, s31, 8192
  s_cmp_eq_u32 s31, 81920
  s_cselect_b32 s31, 32768, s31
  s_add_u32 s32, s32, 10240
  s_cmp_eq_u32 s32, 163840
  s_cselect_b32 s32, 81920, s32
  v_mfma_f32_16x16x32_bf16 v[84:87], v[208:211], v[184:187], v[84:87]
  v_mfma_f32_16x16x32_bf16 v[96:99], v[208:211], v[188:191], v[96:99]
  v_mfma_f32_16x16x32_bf16 v[88:91], v[212:215], v[184:187], v[88:91]
  v_mfma_f32_16x16x32_bf16 v[100:103], v[212:215], v[188:191], v[100:103]
  s_add_u32 s33, s33, 1
  s_cmp_eq_u32 s33, 11
  s_cbranch_scc0 K3_loop_0
  s_waitcnt lgkmcnt(0)
  s_barrier
  v_mfma_f32_16x16x32_bf16 v[80:83], v[144:147], v[128:131], v[80:83]
  v_add_u32 v13, s31, v8
  v_add_u32 v14, s32, v9
  ds_read_b128 v[176:179], v13 offset:0
  v_mfma_f32_16x16x32_bf16 v[92:95], v[144:147], v[132:135], v[92:95]
  ds_read_b128 v[180:183], v13 offset:256
  ds_read_b64_tr_b16 v[192:193], v14 offset:0
  ds_read_b64_tr_b16 v[194:195], v14 offset:1280
  v_mfma_f32_16x16x32_bf16 v[84:87], v[148:151], v[128:131], v[84:87]
  ds_read_b64_tr_b16 v[196:197], v14 offset:32
  ds_read_b64_tr_b16 v[198:199], v14 offset:1312
  v_mfma_f32_16x16x32_bf16 v[96:99], v[148:151], v[132:135], v[96:99]
  ds_read_b64_tr_b16 v[200:201], v14 offset:64
  ds_read_b64_tr_b16 v[202:203], v14 offset:1344
  v_mfma_f32_16x16x32_bf16 v[88:91], v[152:155], v[128:131], v[88:91]
  v_mfma_f32_16x16x32_bf16 v[100:103], v[152:155], v[132:135], v[100:103]
  v_mfma_f32_16x16x32_bf16 v[80:83], v[156:159], v[136:139], v[80:83]
  v_mfma_f32_16x16x32_bf16 v[92:95], v[156:159], v[140:143], v[92:95]
  v_mfma_f32_16x16x32_bf16 v[84:87], v[160:163], v[136:139], v[84:87]
  v_mfma_f32_16x16x32_bf16 v[96:99], v[160:163], v[140:143], v[96:99]
  v_mfma_f32_16x16x32_bf16 v[88:91], v[164:167], v[136:139], v[88:91]
  v_mfma_f32_16x16x32_bf16 v[100:103], v[164:167], v[140:143], v[100:103]
  s_waitcnt lgkmcnt(0)
  v_mfma_f32_16x16x32_bf16 v[80:83], v[192:195], v[176:179], v[80:83]
  v_mfma_f32_16x16x32_bf16 v[92:95], v[192:195], v[180:183], v[92:95]
  v_mfma_f32_16x16x32_bf16 v[84:87], v[196:199], v[176:179], v[84:87]
  v_mfma_f32_16x16x32_bf16 v[96:99], v[196:199], v[180:183], v[96:99]
  v_mfma_f32_16x16x32_bf16 v[88:91], v[200:203], v[176:179], v[88:91]
  v_mfma_f32_16x16x32_bf16 v[100:103], v[200:203], v[180:183], v[100:103]
  s_nop 2
  v_cvt_pk_bf16_f32 v36, v80, v81
  v_cvt_pk_bf16_f32 v37, v82, v83
  buffer_store_dwordx2 v[36:37], v23, s[20:23], s60 offen offset:0
  v_cvt_pk_bf16_f32 v42, v92, v93
  v_cvt_pk_bf16_f32 v43, v94, v95
  buffer_store_dwordx2 v[42:43], v23, s[20:23], s61 offen offset:0
  v_cvt_pk_bf16_f32 v38, v84, v85
  v_cvt_pk_bf16_f32 v39, v86, v87
  buffer_store_dwordx2 v[38:39], v23, s[20:23], s60 offen offset:32
  v_cvt_pk_bf16_f32 v44, v96, v97
  v_cvt_pk_bf16_f32 v45, v98, v99
  buffer_store_dwordx2 v[44:45], v23, s[20:23], s61 offen offset:32
  v_cvt_pk_bf16_f32 v40, v88, v89
  v_cvt_pk_bf16_f32 v41, v90, v91
  buffer_store_dwordx2 v[40:41], v23, s[20:23], s60 offen offset:64
  v_cvt_pk_bf16_f32 v46, v100, v101
  v_cvt_pk_bf16_f32 v47, v102, v103
  buffer_store_dwordx2 v[46:47], v23, s[20:23], s61 offen offset:64
  s_endpgm
K2_cc1:
  v_add_u32 v13, s31, v11
  v_add_u32 v14, s32, v12
  v_xor_b32 v15, 64, v14
  ds_read_b128 v[128:131], v13 offset:0
  ds_read_b128 v[132:135], v13 offset:2048
  ds_read_b64_tr_b16 v[144:145], v14 offset:0
  ds_read_b64_tr_b16 v[146:147], v15 offset:0
  v_xor_b32 v17, 0x80, v14
  v_xor_b32 v18, 0xc0, v14
  ds_read_b64_tr_b16 v[148:149], v17 offset:1024
  ds_read_b64_tr_b16 v[150:151], v18 offset:1024
  ds_read_b64_tr_b16 v[152:153], v14 offset:2048
  ds_read_b64_tr_b16 v[154:155], v15 offset:2048
  v_xor_b32 v16, 64, v13
  ds_read_b128 v[136:139], v16 offset:0
  ds_read_b128 v[140:143], v16 offset:2048
  ds_read_b64_tr_b16 v[160:161], v14 offset:7168
  ds_read_b64_tr_b16 v[162:163], v15 offset:7168
  ds_read_b64_tr_b16 v[164:165], v17 offset:8192
  ds_read_b64_tr_b16 v[166:167], v18 offset:8192
  ds_read_b64_tr_b16 v[168:169], v14 offset:9216
  ds_read_b64_tr_b16 v[170:171], v15 offset:9216
  s_add_u32 s31, s31, 8192
  s_cmp_eq_u32 s31, 81920
  s_cselect_b32 s31, 32768, s31
  s_add_u32 s32, s32, 14336
  s_cmp_eq_u32 s32, 153600
  s_cselect_b32 s32, 81920, s32
  s_mov_b32 s33, 0
  s_lshl_b32 s36, s39, 6
  buffer_load_ushort v19, v31, s[8:11], s36 offen
  buffer_load_ushort v31, v31, s[8:11], s36 offen offset:32
K2_loop_1:
  s_waitcnt lgkmcnt(0)
  s_barrier
  v_mfma_f32_16x16x32_bf16 v[224:227], v[144:147], v[128:131], v[224:227]
  v_add_u32 v13, s31, v11
  v_add_u32 v14, s32, v12
  v_xor_b32 v15, 64, v14
  v_mfma_f32_16x16x32_bf16 v[240:243], v[144:147], v[132:135], v[240:243]
  ds_read_b128 v[176:179], v13 offset:0
  ds_read_b128 v[180:183], v13 offset:2048
  ds_read_b64_tr_b16 v[192:193], v14 offset:0
  v_mfma_f32_16x16x32_bf16 v[228:231], v[148:151], v[128:131], v[228:231]
  ds_read_b64_tr_b16 v[194:195], v15 offset:0
  v_xor_b32 v17, 0x80, v14
  v_xor_b32 v18, 0xc0, v14
  v_mfma_f32_16x16x32_bf16 v[244:247], v[148:151], v[132:135], v[244:247]
  ds_read_b64_tr_b16 v[196:197], v17 offset:1024
  ds_read_b64_tr_b16 v[198:199], v18 offset:1024
  ds_read_b64_tr_b16 v[200:201], v14 offset:2048
  v_mfma_f32_16x16x32_bf16 v[232:235], v[152:155], v[128:131], v[232:235]
  ds_read_b64_tr_b16 v[202:203], v15 offset:2048
  v_xor_b32 v16, 64, v13
  ds_read_b128 v[184:187], v16 offset:0
  v_mfma_f32_16x16x32_bf16 v[248:251], v[152:155], v[132:135], v[248:251]
  ds_read_b128 v[188:191], v16 offset:2048
  ds_read_b64_tr_b16 v[208:209], v14 offset:7168
  ds_read_b64_tr_b16 v[210:211], v15 offset:7168
  v_mfma_f32_16x16x32_bf16 v[224:227], v[160:163], v[136:139], v[224:227]
  ds_read_b64_tr_b16 v[212:213], v17 offset:8192
  ds_read_b64_tr_b16 v[214:215], v18 offset:8192
  ds_read_b64_tr_b16 v[216:217], v14 offset:9216
  v_mfma_f32_16x16x32_bf16 v[240:243], v[160:163], v[140:143], v[240:243]
  ds_read_b64_tr_b16 v[218:219], v15 offset:9216
  s_add_u32 s31, s31, 8192
  s_cmp_eq_u32 s31, 81920
  s_cselect_b32 s31, 32768, s31
  s_add_u32 s32, s32, 14336
  s_cmp_eq_u32 s32, 153600
  s_cselect_b32 s32, 81920, s32
  v_mfma_f32_16x16x32_bf16 v[228:231], v[164:167], v[136:139], v[228:231]
  v_mfma_f32_16x16x32_bf16 v[244:247], v[164:167], v[140:143], v[244:247]
  v_mfma_f32_16x16x32_bf16 v[232:235], v[168:171], v[136:139], v[232:235]
  v_mfma_f32_16x16x32_bf16 v[248:251], v[168:171], v[140:143], v[248:251]
  s_waitcnt lgkmcnt(0)
  s_barrier
  v_mfma_f32_16x16x32_bf16 v[224:227], v[192:195], v[176:179], v[224:227]
  v_add_u32 v13, s31, v11
  v_add_u32 v14, s32, v12
  v_xor_b32 v15, 64, v14
  v_mfma_f32_16x16x32_bf16 v[240:243], v[192:195], v[180:183], v[240:243]
  ds_read_b128 v[128:131], v13 offset:0
  ds_read_b128 v[132:135], v13 offset:2048
  ds_read_b64_tr_b16 v[144:145], v14 offset:0
  v_mfma_f32_16x16x32_bf16 v[228:231], v[196:199], v[176:179], v[228:231]
  ds_read_b64_tr_b16 v[146:147], v15 offset:0
  v_xor_b32 v17, 0x80, v14
  v_xor_b32 v18, 0xc0, v14
  v_mfma_f32_16x16x32_bf16 v[244:247], v[196:199], v[180:183], v[244:247]
  ds_read_b64_tr_b16 v[148:149], v17 offset:1024
  ds_read_b64_tr_b16 v[150:151], v18 offset:1024
  ds_read_b64_tr_b16 v[152:153], v14 offset:2048
  v_mfma_f32_16x16x32_bf16 v[232:235], v[200:203], v[176:179], v[232:235]
  ds_read_b64_tr_b16 v[154:155], v15 offset:2048
  v_xor_b32 v16, 64, v13
  ds_read_b128 v[136:139], v16 offset:0
  v_mfma_f32_16x16x32_bf16 v[248:251], v[200:203], v[180:183], v[248:251]
  ds_read_b128 v[140:143], v16 offset:2048
  ds_read_b64_tr_b16 v[160:161], v14 offset:7168
  ds_read_b64_tr_b16 v[162:163], v15 offset:7168
  v_mfma_f32_16x16x32_bf16 v[224:227], v[208:211], v[184:187], v[224:227]
  ds_read_b64_tr_b16 v[164:165], v17 offset:8192
  ds_read_b64_tr_b16 v[166:167], v18 offset:8192
  ds_read_b64_tr_b16 v[168:169], v14 offset:9216
  v_mfma_f32_16x16x32_bf16 v[240:243], v[208:211], v[188:191], v[240:243]
  ds_read_b64_tr_b16 v[170:171], v15 offset:9216
  s_add_u32 s31, s31, 8192
  s_cmp_eq_u32 s31, 81920
  s_cselect_b32 s31, 32768, s31
  s_add_u32 s32, s32, 14336
  s_cmp_eq_u32 s32, 153600
  s_cselect_b32 s32, 81920, s32
  v_mfma_f32_16x16x32_bf16 v[228:231], v[212:215], v[184:187], v[228:231]
  v_mfma_f32_16x16x32_bf16 v[244:247], v[212:215], v[188:191], v[244:247]
  v_mfma_f32_16x16x32_bf16 v[232:235], v[216:219], v[184:187], v[232:235]
  v_mfma_f32_16x16x32_bf16 v[248:251], v[216:219], v[188:191], v[248:251]
  s_add_u32 s33, s33, 1
  s_cmp_eq_u32 s33, 15
  s_cbranch_scc0 K2_loop_1
  s_waitcnt lgkmcnt(0)
  s_barrier
  v_mfma_f32_16x16x32_bf16 v[224:227], v[144:147], v[128:131], v[224:227]
  v_add_u32 v13, s31, v11
  v_add_u32 v14, s32, v12
  v_xor_b32 v15, 64, v14
  ds_read_b128 v[176:179], v13 offset:0
  v_mfma_f32_16x16x32_bf16 v[240:243], v[144:147], v[132:135], v[240:243]
  ds_read_b128 v[180:183], v13 offset:2048
  ds_read_b64_tr_b16 v[192:193], v14 offset:0
  ds_read_b64_tr_b16 v[194:195], v15 offset:0
  v_xor_b32 v17, 0x80, v14
  v_mfma_f32_16x16x32_bf16 v[228:231], v[148:151], v[128:131], v[228:231]
  v_xor_b32 v18, 0xc0, v14
  ds_read_b64_tr_b16 v[196:197], v17 offset:1024
  ds_read_b64_tr_b16 v[198:199], v18 offset:1024
  ds_read_b64_tr_b16 v[200:201], v14 offset:2048
  v_mfma_f32_16x16x32_bf16 v[244:247], v[148:151], v[132:135], v[244:247]
  ds_read_b64_tr_b16 v[202:203], v15 offset:2048
  v_xor_b32 v16, 64, v13
  ds_read_b128 v[184:187], v16 offset:0
  ds_read_b128 v[188:191], v16 offset:2048
  v_mfma_f32_16x16x32_bf16 v[232:235], v[152:155], v[128:131], v[232:235]
  ds_read_b64_tr_b16 v[208:209], v14 offset:7168
  ds_read_b64_tr_b16 v[210:211], v15 offset:7168
  ds_read_b64_tr_b16 v[212:213], v17 offset:8192
  v_mfma_f32_16x16x32_bf16 v[248:251], v[152:155], v[132:135], v[248:251]
  ds_read_b64_tr_b16 v[214:215], v18 offset:8192
  ds_read_b64_tr_b16 v[216:217], v14 offset:9216
  ds_read_b64_tr_b16 v[218:219], v15 offset:9216
  v_mfma_f32_16x16x32_bf16 v[224:227], v[160:163], v[136:139], v[224:227]
  s_add_u32 s31, s31, 8192
  s_cmp_eq_u32 s31, 81920
  s_cselect_b32 s31, 32768, s31
  s_add_u32 s32, s32, 14336
  s_cmp_eq_u32 s32, 153600
  s_cselect_b32 s32, 81920, s32
  ds_read_b64 v[36:37], v20 offset:0
  v_mfma_f32_16x16x32_bf16 v[240:243], v[160:163], v[140:143], v[240:243]
  ds_read_b64 v[38:39], v20 offset:32
  ds_read_b64 v[42:43], v20 offset:4096
  ds_read_b64 v[44:45], v20 offset:4128
  v_mfma_f32_16x16x32_bf16 v[228:231], v[164:167], v[136:139], v[228:231]
  v_mfma_f32_16x16x32_bf16 v[244:247], v[164:167], v[140:143], v[244:247]
  v_mfma_f32_16x16x32_bf16 v[232:235], v[168:171], v[136:139], v[232:235]
  v_mfma_f32_16x16x32_bf16 v[248:251], v[168:171], v[140:143], v[248:251]
  s_waitcnt lgkmcnt(0)
  s_barrier
  v_mfma_f32_16x16x32_bf16 v[224:227], v[192:195], v[176:179], v[224:227]
  s_mul_i32 s36, s27, 7168
  v_add_u32 v21, s36, v21
  v_add_u32 v22, s36, v22
  v_mfma_f32_16x16x32_bf16 v[240:243], v[192:195], v[180:183], v[240:243]
  ds_read_b64 v[112:113], v21 offset:20480
  ds_read_b64 v[120:121], v21 offset:20736
  v_mfma_f32_16x16x32_bf16 v[228:231], v[196:199], v[176:179], v[228:231]
  ds_read_b64 v[114:115], v22 offset:21504
  ds_read_b64 v[122:123], v22 offset:21760
  v_mfma_f32_16x16x32_bf16 v[244:247], v[196:199], v[180:183], v[244:247]
  ds_read_b64 v[116:117], v21 offset:22528
  ds_read_b64 v[124:125], v21 offset:22784
  v_mfma_f32_16x16x32_bf16 v[232:235], v[200:203], v[176:179], v[232:235]
  v_lshlrev_b32 v80, 16, v36
  v_and_b32 v81, 0xffff0000, v36
  v_mfma_f32_16x16x32_bf16 v[248:251], v[200:203], v[180:183], v[248:251]
  v_lshlrev_b32 v82, 16, v37
  v_and_b32 v83, 0xffff0000, v37
  v_mfma_f32_16x16x32_bf16 v[224:227], v[208:211], v[184:187], v[224:227]
  v_lshlrev_b32 v84, 16, v38
  v_and_b32 v85, 0xffff0000, v38
  v_mfma_f32_16x16x32_bf16 v[240:243], v[208:211], v[188:191], v[240:243]
  v_lshlrev_b32 v86, 16, v39
  v_and_b32 v87, 0xffff0000, v39
  v_mfma_f32_16x16x32_bf16 v[228:231], v[212:215], v[184:187], v[228:231]
  v_lshlrev_b32 v92, 16, v42
  v_and_b32 v93, 0xffff0000, v42
  v_mfma_f32_16x16x32_bf16 v[244:247], v[212:215], v[188:191], v[244:247]
  v_lshlrev_b32 v94, 16, v43
  v_and_b32 v95, 0xffff0000, v43
  v_mfma_f32_16x16x32_bf16 v[232:235], v[216:219], v[184:187], v[232:235]
  v_lshlrev_b32 v96, 16, v44
  v_and_b32 v97, 0xffff0000, v44
  v_mfma_f32_16x16x32_bf16 v[248:251], v[216:219], v[188:191], v[248:251]
  v_lshlrev_b32 v98, 16, v45
  v_and_b32 v99, 0xffff0000, v45
  s_waitcnt lgkmcnt(0)
  s_mov_b32 s32, 153600
  s_waitcnt vmcnt(0)
  v_lshlrev_b32 v19, 16, v19
  s_mul_i32 s36, s39, 94
  s_add_u32 s36, s36, s45
  s_lshl_b32 s36, s36, 10
  s_add_u32 s36, s36, 15245312
  v_lshlrev_b32 v31, 16, v31
  v_lshlrev_b32 v24, 16, v112
  v_and_b32 v25, 0xffff0000, v112
  v_add_f32 v224, v224, v19
  v_add_f32 v225, v225, v19
  v_mul_f32 v24, v24, v224
  v_mul_f32 v25, v25, v225
  v_cvt_pk_bf16_f32 v112, v24, v25
  v_lshlrev_b32 v26, 16, v113
  v_and_b32 v27, 0xffff0000, v113
  v_add_f32 v226, v226, v19
  v_add_f32 v227, v227, v19
  v_mul_f32 v26, v26, v226
  v_mul_f32 v27, v27, v227
  v_cvt_pk_bf16_f32 v113, v26, v27
  buffer_store_dwordx2 v[112:113], v30, s[16:19], s36 offen offset:0 sc1
  v_lshlrev_b32 v24, 16, v120
  v_and_b32 v25, 0xffff0000, v120
  v_add_f32 v240, v240, v31
  v_add_f32 v241, v241, v31
  v_mul_f32 v24, v24, v240
  v_mul_f32 v25, v25, v241
  v_cvt_pk_bf16_f32 v120, v24, v25
  v_lshlrev_b32 v26, 16, v121
  v_and_b32 v27, 0xffff0000, v121
  v_add_f32 v242, v242, v31
  v_add_f32 v243, v243, v31
  v_mul_f32 v26, v26, v242
  v_mul_f32 v27, v27, v243
  v_cvt_pk_bf16_f32 v121, v26, v27
  buffer_store_dwordx2 v[120:121], v30, s[16:19], s36 offen offset:256 sc1
  s_cmp_eq_u32 s45, 53
  s_cbranch_scc1 K2_done_1
  v_lshlrev_b32 v24, 16, v114
  v_and_b32 v25, 0xffff0000, v114
  v_add_f32 v228, v228, v19
  v_add_f32 v229, v229, v19
  v_mul_f32 v24, v24, v228
  v_mul_f32 v25, v25, v229
  v_cvt_pk_bf16_f32 v114, v24, v25
  v_lshlrev_b32 v26, 16, v115
  v_and_b32 v27, 0xffff0000, v115
  v_add_f32 v230, v230, v19
  v_add_f32 v231, v231, v19
  v_mul_f32 v26, v26, v230
  v_mul_f32 v27, v27, v231
  v_cvt_pk_bf16_f32 v115, v26, v27
  buffer_store_dwordx2 v[114:115], v30, s[16:19], s36 offen offset:1024 sc1
  v_lshlrev_b32 v24, 16, v122
  v_and_b32 v25, 0xffff0000, v122
  v_add_f32 v244, v244, v31
  v_add_f32 v245, v245, v31
  v_mul_f32 v24, v24, v244
  v_mul_f32 v25, v25, v245
  v_cvt_pk_bf16_f32 v122, v24, v25
  v_lshlrev_b32 v26, 16, v123
  v_and_b32 v27, 0xffff0000, v123
  v_add_f32 v246, v246, v31
  v_add_f32 v247, v247, v31
  v_mul_f32 v26, v26, v246
  v_mul_f32 v27, v27, v247
  v_cvt_pk_bf16_f32 v123, v26, v27
  buffer_store_dwordx2 v[122:123], v30, s[16:19], s36 offen offset:1280 sc1
  v_lshlrev_b32 v24, 16, v116
  v_and_b32 v25, 0xffff0000, v116
  v_add_f32 v232, v232, v19
  v_add_f32 v233, v233, v19
  v_mul_f32 v24, v24, v232
  v_mul_f32 v25, v25, v233
  v_cvt_pk_bf16_f32 v116, v24, v25
  v_lshlrev_b32 v26, 16, v117
  v_and_b32 v27, 0xffff0000, v117
  v_add_f32 v234, v234, v19
  v_add_f32 v235, v235, v19
  v_mul_f32 v26, v26, v234
  v_mul_f32 v27, v27, v235
  v_cvt_pk_bf16_f32 v117, v26, v27
  buffer_store_dwordx2 v[116:117], v30, s[16:19], s36 offen offset:2048 sc1
  v_lshlrev_b32 v24, 16, v124
  v_and_b32 v25, 0xffff0000, v124
  v_add_f32 v248, v248, v31
  v_add_f32 v249, v249, v31
  v_mul_f32 v24, v24, v248
  v_mul_f32 v25, v25, v249
  v_cvt_pk_bf16_f32 v124, v24, v25
  v_lshlrev_b32 v26, 16, v125
  v_and_b32 v27, 0xffff0000, v125
  v_add_f32 v250, v250, v31
  v_add_f32 v251, v251, v31
  v_mul_f32 v26, v26, v250
  v_mul_f32 v27, v27, v251
  v_cvt_pk_bf16_f32 v125, v26, v27
  buffer_store_dwordx2 v[124:125], v30, s[16:19], s36 offen offset:2304 sc1
K2_done_1:
  s_add_u32 s59, s59, 4096
  s_barrier
  v_add_u32 v13, s31, v8
  v_add_u32 v14, s32, v9
  ds_read_b128 v[128:131], v13 offset:0
  ds_read_b128 v[132:135], v13 offset:256
  ds_read_b64_tr_b16 v[144:145], v14 offset:0
  ds_read_b64_tr_b16 v[146:147], v14 offset:1280
  ds_read_b64_tr_b16 v[148:149], v14 offset:32
  ds_read_b64_tr_b16 v[150:151], v14 offset:1312
  ds_read_b128 v[136:139], v13 offset:2048
  ds_read_b128 v[140:143], v13 offset:2304
  ds_read_b64_tr_b16 v[156:157], v14 offset:5120
  ds_read_b64_tr_b16 v[158:159], v14 offset:6400
  ds_read_b64_tr_b16 v[160:161], v14 offset:5152
  ds_read_b64_tr_b16 v[162:163], v14 offset:6432
  s_add_u32 s31, s31, 8192
  s_cmp_eq_u32 s31, 81920
  s_cselect_b32 s31, 32768, s31
  s_add_u32 s32, s32, 10240
  s_cmp_eq_u32 s32, 163840
  s_cselect_b32 s32, 81920, s32
  s_waitcnt lgkmcnt(0)
  s_barrier
  v_mfma_f32_16x16x32_bf16 v[80:83], v[144:147], v[128:131], v[80:83]
  v_add_u32 v13, s31, v8
  v_add_u32 v14, s32, v9
  ds_read_b128 v[176:179], v13 offset:0
  ds_read_b128 v[180:183], v13 offset:256
  v_mfma_f32_16x16x32_bf16 v[92:95], v[144:147], v[132:135], v[92:95]
  ds_read_b64_tr_b16 v[192:193], v14 offset:0
  ds_read_b64_tr_b16 v[194:195], v14 offset:1280
  ds_read_b64_tr_b16 v[196:197], v14 offset:32
  v_mfma_f32_16x16x32_bf16 v[84:87], v[148:151], v[128:131], v[84:87]
  ds_read_b64_tr_b16 v[198:199], v14 offset:1312
  ds_read_b128 v[184:187], v13 offset:2048
  ds_read_b128 v[188:191], v13 offset:2304
  v_mfma_f32_16x16x32_bf16 v[96:99], v[148:151], v[132:135], v[96:99]
  ds_read_b64_tr_b16 v[204:205], v14 offset:5120
  ds_read_b64_tr_b16 v[206:207], v14 offset:6400
  ds_read_b64_tr_b16 v[208:209], v14 offset:5152
  v_mfma_f32_16x16x32_bf16 v[80:83], v[156:159], v[136:139], v[80:83]
  ds_read_b64_tr_b16 v[210:211], v14 offset:6432
  s_add_u32 s31, s31, 8192
  s_cmp_eq_u32 s31, 81920
  s_cselect_b32 s31, 32768, s31
  s_add_u32 s32, s32, 10240
  s_cmp_eq_u32 s32, 163840
  s_cselect_b32 s32, 81920, s32
  v_mfma_f32_16x16x32_bf16 v[92:95], v[156:159], v[140:143], v[92:95]
  v_mfma_f32_16x16x32_bf16 v[84:87], v[160:163], v[136:139], v[84:87]
  v_mfma_f32_16x16x32_bf16 v[96:99], v[160:163], v[140:143], v[96:99]
  s_waitcnt lgkmcnt(0)
  s_barrier
  v_mfma_f32_16x16x32_bf16 v[80:83], v[192:195], v[176:179], v[80:83]
  v_add_u32 v13, s31, v8
  v_add_u32 v14, s32, v9
  ds_read_b128 v[128:131], v13 offset:0
  ds_read_b128 v[132:135], v13 offset:256
  v_mfma_f32_16x16x32_bf16 v[92:95], v[192:195], v[180:183], v[92:95]
  ds_read_b64_tr_b16 v[144:145], v14 offset:0
  ds_read_b64_tr_b16 v[146:147], v14 offset:1280
  ds_read_b64_tr_b16 v[148:149], v14 offset:32
  v_mfma_f32_16x16x32_bf16 v[84:87], v[196:199], v[176:179], v[84:87]
  ds_read_b64_tr_b16 v[150:151], v14 offset:1312
  ds_read_b128 v[136:139], v13 offset:2048
  ds_read_b128 v[140:143], v13 offset:2304
  v_mfma_f32_16x16x32_bf16 v[96:99], v[196:199], v[180:183], v[96:99]
  ds_read_b64_tr_b16 v[156:157], v14 offset:5120
  ds_read_b64_tr_b16 v[158:159], v14 offset:6400
  ds_read_b64_tr_b16 v[160:161], v14 offset:5152
  v_mfma_f32_16x16x32_bf16 v[80:83], v[204:207], v[184:187], v[80:83]
  ds_read_b64_tr_b16 v[162:163], v14 offset:6432
  s_add_u32 s31, s31, 8192
  s_cmp_eq_u32 s31, 81920
  s_cselect_b32 s31, 32768, s31
  s_add_u32 s32, s32, 10240
  s_cmp_eq_u32 s32, 163840
  s_cselect_b32 s32, 81920, s32
  v_mfma_f32_16x16x32_bf16 v[92:95], v[204:207], v[188:191], v[92:95]
  v_mfma_f32_16x16x32_bf16 v[84:87], v[208:211], v[184:187], v[84:87]
  v_mfma_f32_16x16x32_bf16 v[96:99], v[208:211], v[188:191], v[96:99]
  s_waitcnt vmcnt(0)
  v_mov_b32 v24, 1
  v_mov_b32 v25, 0
  s_mov_b64 exec, 1
  buffer_atomic_add v24, v25, s[16:19], s59 offen offset:0 sc1
  s_mov_b64 exec, -1
  s_mov_b32 s33, 1
K3_loop_1:
  s_waitcnt lgkmcnt(0)
  s_barrier
  v_mfma_f32_16x16x32_bf16 v[80:83], v[144:147], v[128:131], v[80:83]
  v_add_u32 v13, s31, v8
  v_add_u32 v14, s32, v9
  ds_read_b128 v[176:179], v13 offset:0
  ds_read_b128 v[180:183], v13 offset:256
  v_mfma_f32_16x16x32_bf16 v[92:95], v[144:147], v[132:135], v[92:95]
  ds_read_b64_tr_b16 v[192:193], v14 offset:0
  ds_read_b64_tr_b16 v[194:195], v14 offset:1280
  ds_read_b64_tr_b16 v[196:197], v14 offset:32
  v_mfma_f32_16x16x32_bf16 v[84:87], v[148:151], v[128:131], v[84:87]
  ds_read_b64_tr_b16 v[198:199], v14 offset:1312
  ds_read_b128 v[184:187], v13 offset:2048
  ds_read_b128 v[188:191], v13 offset:2304
  v_mfma_f32_16x16x32_bf16 v[96:99], v[148:151], v[132:135], v[96:99]
  ds_read_b64_tr_b16 v[204:205], v14 offset:5120
  ds_read_b64_tr_b16 v[206:207], v14 offset:6400
  ds_read_b64_tr_b16 v[208:209], v14 offset:5152
  v_mfma_f32_16x16x32_bf16 v[80:83], v[156:159], v[136:139], v[80:83]
  ds_read_b64_tr_b16 v[210:211], v14 offset:6432
  s_add_u32 s31, s31, 8192
  s_cmp_eq_u32 s31, 81920
  s_cselect_b32 s31, 32768, s31
  s_add_u32 s32, s32, 10240
  s_cmp_eq_u32 s32, 163840
  s_cselect_b32 s32, 81920, s32
  v_mfma_f32_16x16x32_bf16 v[92:95], v[156:159], v[140:143], v[92:95]
  v_mfma_f32_16x16x32_bf16 v[84:87], v[160:163], v[136:139], v[84:87]
  v_mfma_f32_16x16x32_bf16 v[96:99], v[160:163], v[140:143], v[96:99]
  s_waitcnt lgkmcnt(0)
  s_barrier
  v_mfma_f32_16x16x32_bf16 v[80:83], v[192:195], v[176:179], v[80:83]
  v_add_u32 v13, s31, v8
  v_add_u32 v14, s32, v9
  ds_read_b128 v[128:131], v13 offset:0
  ds_read_b128 v[132:135], v13 offset:256
  v_mfma_f32_16x16x32_bf16 v[92:95], v[192:195], v[180:183], v[92:95]
  ds_read_b64_tr_b16 v[144:145], v14 offset:0
  ds_read_b64_tr_b16 v[146:147], v14 offset:1280
  ds_read_b64_tr_b16 v[148:149], v14 offset:32
  v_mfma_f32_16x16x32_bf16 v[84:87], v[196:199], v[176:179], v[84:87]
  ds_read_b64_tr_b16 v[150:151], v14 offset:1312
  ds_read_b128 v[136:139], v13 offset:2048
  ds_read_b128 v[140:143], v13 offset:2304
  v_mfma_f32_16x16x32_bf16 v[96:99], v[196:199], v[180:183], v[96:99]
  ds_read_b64_tr_b16 v[156:157], v14 offset:5120
  ds_read_b64_tr_b16 v[158:159], v14 offset:6400
  ds_read_b64_tr_b16 v[160:161], v14 offset:5152
  v_mfma_f32_16x16x32_bf16 v[80:83], v[204:207], v[184:187], v[80:83]
  ds_read_b64_tr_b16 v[162:163], v14 offset:6432
  s_add_u32 s31, s31, 8192
  s_cmp_eq_u32 s31, 81920
  s_cselect_b32 s31, 32768, s31
  s_add_u32 s32, s32, 10240
  s_cmp_eq_u32 s32, 163840
  s_cselect_b32 s32, 81920, s32
  v_mfma_f32_16x16x32_bf16 v[92:95], v[204:207], v[188:191], v[92:95]
  v_mfma_f32_16x16x32_bf16 v[84:87], v[208:211], v[184:187], v[84:87]
  v_mfma_f32_16x16x32_bf16 v[96:99], v[208:211], v[188:191], v[96:99]
  s_add_u32 s33, s33, 1
  s_cmp_eq_u32 s33, 11
  s_cbranch_scc0 K3_loop_1
  s_waitcnt lgkmcnt(0)
  s_barrier
  v_mfma_f32_16x16x32_bf16 v[80:83], v[144:147], v[128:131], v[80:83]
  v_add_u32 v13, s31, v8
  v_add_u32 v14, s32, v9
  ds_read_b128 v[176:179], v13 offset:0
  v_mfma_f32_16x16x32_bf16 v[92:95], v[144:147], v[132:135], v[92:95]
  ds_read_b128 v[180:183], v13 offset:256
  ds_read_b64_tr_b16 v[192:193], v14 offset:0
  ds_read_b64_tr_b16 v[194:195], v14 offset:1280
  v_mfma_f32_16x16x32_bf16 v[84:87], v[148:151], v[128:131], v[84:87]
  ds_read_b64_tr_b16 v[196:197], v14 offset:32
  ds_read_b64_tr_b16 v[198:199], v14 offset:1312
  v_mfma_f32_16x16x32_bf16 v[96:99], v[148:151], v[132:135], v[96:99]
  v_mfma_f32_16x16x32_bf16 v[80:83], v[156:159], v[136:139], v[80:83]
  v_mfma_f32_16x16x32_bf16 v[92:95], v[156:159], v[140:143], v[92:95]
  v_mfma_f32_16x16x32_bf16 v[84:87], v[160:163], v[136:139], v[84:87]
  v_mfma_f32_16x16x32_bf16 v[96:99], v[160:163], v[140:143], v[96:99]
  s_waitcnt lgkmcnt(0)
  v_mfma_f32_16x16x32_bf16 v[80:83], v[192:195], v[176:179], v[80:83]
  v_mfma_f32_16x16x32_bf16 v[92:95], v[192:195], v[180:183], v[92:95]
  v_mfma_f32_16x16x32_bf16 v[84:87], v[196:199], v[176:179], v[84:87]
  v_mfma_f32_16x16x32_bf16 v[96:99], v[196:199], v[180:183], v[96:99]
  s_nop 4
  v_cvt_pk_bf16_f32 v36, v80, v81
  v_cvt_pk_bf16_f32 v37, v82, v83
  buffer_store_dwordx2 v[36:37], v23, s[20:23], s60 offen offset:0
  v_cvt_pk_bf16_f32 v42, v92, v93
  v_cvt_pk_bf16_f32 v43, v94, v95
  buffer_store_dwordx2 v[42:43], v23, s[20:23], s61 offen offset:0
  v_cvt_pk_bf16_f32 v38, v84, v85
  v_cvt_pk_bf16_f32 v39, v86, v87
  buffer_store_dwordx2 v[38:39], v23, s[20:23], s60 offen offset:32
  v_cvt_pk_bf16_f32 v44, v96, v97
  v_cvt_pk_bf16_f32 v45, v98, v99
  buffer_store_dwordx2 v[44:45], v23, s[20:23], s61 offen offset:32
  s_endpgm
K1_tail:
  s_waitcnt lgkmcnt(0)
  s_barrier
  ds_read_b128 v[36:39], v3
  s_waitcnt lgkmcnt(0)
  v_add_f32 v36, v36, v37
  v_add_f32 v38, v38, v39
  v_add_f32 v36, v36, v38
  v_add_u32 v3, s34, v3
  s_nop 0
  v_mfma_f32_32x32x2_f32 v[64:79], v36, v19, v[64:79]
  s_add_u32 s71, s68, 1024
  s_mov_b32 s70, s56
  s_mov_b32 s69, s38
  s_nop 3
  s_nop 10
  v_mul_f32 v28, v64, v64
  v_fma_f32 v28, v28, v15, v16
  v_mul_f32 v29, v65, v65
  v_mul_f32 v28, v28, v64
  v_fma_f32 v29, v29, v15, v16
  v_mul_f32 v30, v66, v66
  v_exp_f32 v28, v28
  v_mul_f32 v29, v29, v65
  v_fma_f32 v30, v30, v15, v16
  v_mul_f32 v31, v67, v67
  v_fma_f32 v28, v28, v14, v14
  v_exp_f32 v29, v29
  v_mul_f32 v30, v30, v66
  v_fma_f32 v31, v31, v15, v16
  v_mul_f32 v32, v68, v68
  v_rcp_f32 v28, v28
  v_fma_f32 v29, v29, v14, v14
  v_exp_f32 v30, v30
  v_mul_f32 v31, v31, v67
  v_fma_f32 v32, v32, v15, v16
  v_mul_f32 v33, v69, v69
  v_mul_f32 v64, v64, v28
  v_rcp_f32 v29, v29
  v_fma_f32 v30, v30, v14, v14
  v_exp_f32 v31, v31
  v_mul_f32 v32, v32, v68
  v_fma_f32 v33, v33, v15, v16
  v_mul_f32 v34, v70, v70
  v_mul_f32 v65, v65, v29
  v_rcp_f32 v30, v30
  v_fma_f32 v31, v31, v14, v14
  v_exp_f32 v32, v32
  v_mul_f32 v33, v33, v69
  v_fma_f32 v34, v34, v15, v16
  v_mul_f32 v35, v71, v71
  v_cvt_pk_bf16_f32 v36, v64, v65
  v_mul_f32 v66, v66, v30
  v_rcp_f32 v31, v31
  v_fma_f32 v32, v32, v14, v14
  v_exp_f32 v33, v33
  v_mul_f32 v34, v34, v70
  v_fma_f32 v35, v35, v15, v16
  v_mul_f32 v28, v72, v72
  v_mul_f32 v67, v67, v31
  v_rcp_f32 v32, v32
  v_fma_f32 v33, v33, v14, v14
  v_exp_f32 v34, v34
  v_mul_f32 v35, v35, v71
  v_fma_f32 v28, v28, v15, v16
  v_mul_f32 v29, v73, v73
  v_cvt_pk_bf16_f32 v37, v66, v67
  v_mul_f32 v68, v68, v32
  v_rcp_f32 v33, v33
  v_fma_f32 v34, v34, v14, v14
  v_exp_f32 v35, v35
  v_mul_f32 v28, v28, v72
  v_fma_f32 v29, v29, v15, v16
  v_mul_f32 v30, v74, v74
  v_mul_f32 v69, v69, v33
  v_rcp_f32 v34, v34
  v_fma_f32 v35, v35, v14, v14
  v_exp_f32 v28, v28
  v_mul_f32 v29, v29, v73
  v_fma_f32 v30, v30, v15, v16
  v_mul_f32 v31, v75, v75
  v_cvt_pk_bf16_f32 v38, v68, v69
  v_mul_f32 v70, v70, v34
  v_rcp_f32 v35, v35
  v_fma_f32 v28, v28, v14, v14
  v_exp_f32 v29, v29
  v_mul_f32 v30, v30, v74
  v_fma_f32 v31, v31, v15, v16
  v_mul_f32 v32, v76, v76
  v_mul_f32 v71, v71, v35
  v_rcp_f32 v28, v28
  v_fma_f32 v29, v29, v14, v14
  v_exp_f32 v30, v30
  v_mul_f32 v31, v31, v75
  v_fma_f32 v32, v32, v15, v16
  v_mul_f32 v33, v77, v77
  v_cvt_pk_bf16_f32 v39, v70, v71
  v_mul_f32 v72, v72, v28
  v_rcp_f32 v29, v29
  v_fma_f32 v30, v30, v14, v14
  v_exp_f32 v31, v31
  v_mul_f32 v32, v32, v76
  v_fma_f32 v33, v33, v15, v16
  v_mul_f32 v34, v78, v78
  buffer_store_dwordx4 v[36:39], v5, s[16:19], s43 offen sc1
  v_mul_f32 v73, v73, v29
  v_rcp_f32 v30, v30
  v_fma_f32 v31, v31, v14, v14
  v_exp_f32 v32, v32
  v_mul_f32 v33, v33, v77
  v_fma_f32 v34, v34, v15, v16
  v_mul_f32 v35, v79, v79
  v_cvt_pk_bf16_f32 v36, v72, v73
  v_mul_f32 v74, v74, v30
  v_rcp_f32 v31, v31
  v_fma_f32 v32, v32, v14, v14
  v_exp_f32 v33, v33
  v_mul_f32 v34, v34, v78
  v_fma_f32 v35, v35, v15, v16
  v_mul_f32 v75, v75, v31
  v_rcp_f32 v32, v32
  v_fma_f32 v33, v33, v14, v14
  v_exp_f32 v34, v34
  v_mul_f32 v35, v35, v79
  v_cvt_pk_bf16_f32 v37, v74, v75
  v_mul_f32 v76, v76, v32
  v_rcp_f32 v33, v33
  v_fma_f32 v34, v34, v14, v14
  v_exp_f32 v35, v35
  v_mul_f32 v77, v77, v33
  v_rcp_f32 v34, v34
  v_fma_f32 v35, v35, v14, v14
  v_cvt_pk_bf16_f32 v38, v76, v77
  v_mul_f32 v78, v78, v34
  v_rcp_f32 v35, v35
  s_nop 0
  v_mul_f32 v79, v79, v35
  v_cvt_pk_bf16_f32 v39, v78, v79
  buffer_store_dwordx4 v[36:39], v4, s[16:19], s43 offen sc1
  s_branch P2_late
K1_bodyP:
  s_waitcnt lgkmcnt(4)
  s_waitcnt vmcnt(14)
  s_barrier
  v_mfma_f32_32x32x16_bf16 v[80:95], v[48:51], v[96:99], 0
  ds_read_b128 v[36:39], v3
  ds_read_b64_tr_b16 v[60:61], v11 offset:0
  ds_read_b64_tr_b16 v[62:63], v11 offset:512
  s_add_u32 m0, s35, 8192
  s_nop 0
  buffer_load_dword v1, s[4:7], s29 offen lds
  s_add_u32 s29, s29, 1024
  buffer_load_dwordx4 v7, s[12:15], s31 offen lds
  v_mfma_f32_16x16x32_bf16 v[20:23], v[24:27], v[48:51], 0
  s_waitcnt lgkmcnt(5)
  v_mfma_f32_32x32x16_bf16 v[80:95], v[52:55], v[100:103], v[80:95]
  ds_read_b64_tr_b16 v[48:49], v8 offset:2048
  ds_read_b64_tr_b16 v[50:51], v8 offset:2560
  v_lshlrev_b32 v1, 3, v0
  s_waitcnt lgkmcnt(5)
  v_mfma_f32_32x32x16_bf16 v[80:95], v[56:59], v[104:107], v[80:95]
  ds_read_b64_tr_b16 v[52:53], v9 offset:2048
  ds_read_b64_tr_b16 v[54:55], v9 offset:2560
  s_waitcnt lgkmcnt(6)
  v_add_f32 v36, v36, v37
  v_add_f32 v38, v38, v39
  v_add_f32 v36, v36, v38
  v_add_u32 v3, s34, v3
  s_nop 0
  v_mfma_f32_32x32x2_f32 v[64:79], v36, v19, v[64:79]
  s_sub_u32 s34, 0, s34
  s_waitcnt lgkmcnt(4)
  v_mfma_f32_32x32x16_bf16 v[80:95], v[60:63], v[108:111], v[80:95]
  ds_read_b64_tr_b16 v[56:57], v10 offset:2048
  ds_read_b64_tr_b16 v[58:59], v10 offset:2560
  s_waitcnt lgkmcnt(4)
  v_mfma_f32_32x32x16_bf16 v[80:95], v[48:51], v[112:115], v[80:95]
  ds_read_b64_tr_b16 v[60:61], v11 offset:2048
  ds_read_b64_tr_b16 v[62:63], v11 offset:2560
  buffer_load_dwordx4 v6, s[12:15], s31 offen offset:1024 lds
  s_add_u32 s31, s31, 491520
  v_mfma_f32_16x16x32_bf16 v[20:23], v[24:27], v[48:51], v[20:23]
  s_waitcnt lgkmcnt(4)
  v_mfma_f32_32x32x16_bf16 v[80:95], v[52:55], v[116:119], v[80:95]
  ds_read_b64_tr_b16 v[48:49], v8 offset:4096
  ds_read_b64_tr_b16 v[50:51], v8 offset:4608
  s_waitcnt lgkmcnt(4)
  v_mfma_f32_32x32x16_bf16 v[80:95], v[56:59], v[120:123], v[80:95]
  ds_read_b64_tr_b16 v[52:53], v9 offset:4096
  ds_read_b64_tr_b16 v[54:55], v9 offset:4608
  v_mul_f32 v28, v64, v17
  v_exp_f32 v28, v28 clamp
  v_mul_f32 v29, v65, v17
  s_waitcnt lgkmcnt(4)
  v_mfma_f32_32x32x16_bf16 v[80:95], v[60:63], v[124:127], v[80:95]
  ds_read_b64_tr_b16 v[56:57], v10 offset:4096
  ds_read_b64_tr_b16 v[58:59], v10 offset:4608
  v_fma_f32 v64, v64, v18, s42
  v_exp_f32 v29, v29 clamp
  v_mul_f32 v30, v66, v17
  s_waitcnt vmcnt(15)
  s_barrier
  s_waitcnt lgkmcnt(4)
  v_mfma_f32_32x32x16_bf16 v[80:95], v[48:51], v[128:131], v[80:95]
  ds_read_b64_tr_b16 v[60:61], v11 offset:4096
  ds_read_b64_tr_b16 v[62:63], v11 offset:4608
  s_add_u32 m0, s35, 12288
  v_max_f32 v64, s40, v64
  v_fma_f32 v65, v65, v18, s42
  v_exp_f32 v30, v30 clamp
  buffer_load_dwordx4 v7, s[12:15], s31 offen lds
  v_mfma_f32_16x16x32_bf16 v[20:23], v[24:27], v[48:51], v[20:23]
  s_waitcnt lgkmcnt(4)
  v_mfma_f32_32x32x16_bf16 v[80:95], v[52:55], v[132:135], v[80:95]
  ds_read_b64_tr_b16 v[48:49], v8 offset:6144
  ds_read_b64_tr_b16 v[50:51], v8 offset:6656
  v_mul_f32 v31, v67, v17
  v_fma_f32 v64, v28, s41, v64
  v_max_f32 v65, s40, v65
  s_waitcnt lgkmcnt(4)
  v_mfma_f32_32x32x16_bf16 v[80:95], v[56:59], v[136:139], v[80:95]
  ds_read_b64_tr_b16 v[52:53], v9 offset:6144
  ds_read_b64_tr_b16 v[54:55], v9 offset:6656
  v_fma_f32 v66, v66, v18, s42
  v_exp_f32 v31, v31 clamp
  v_mul_f32 v32, v68, v17
  s_waitcnt lgkmcnt(4)
  v_mfma_f32_32x32x16_bf16 v[80:95], v[60:63], v[140:143], v[80:95]
  ds_read_b64_tr_b16 v[56:57], v10 offset:6144
  ds_read_b64_tr_b16 v[58:59], v10 offset:6656
  v_fma_f32 v65, v29, s41, v65
  v_max_f32 v66, s40, v66
  v_fma_f32 v67, v67, v18, s42
  s_waitcnt lgkmcnt(4)
  v_mfma_f32_32x32x16_bf16 v[80:95], v[48:51], v[144:147], v[80:95]
  ds_read_b64_tr_b16 v[60:61], v11 offset:6144
  ds_read_b64_tr_b16 v[62:63], v11 offset:6656
  v_exp_f32 v32, v32 clamp
  v_mul_f32 v33, v69, v17
  v_cvt_pk_bf16_f32 v36, v64, v65
  buffer_load_dwordx4 v6, s[12:15], s31 offen offset:1024 lds
  s_add_u32 s31, s31, 491520
  v_mfma_f32_16x16x32_bf16 v[20:23], v[24:27], v[48:51], v[20:23]
  s_waitcnt lgkmcnt(4)
  v_mfma_f32_32x32x16_bf16 v[80:95], v[52:55], v[148:151], v[80:95]
  ds_read_b64_tr_b16 v[48:49], v8 offset:8192
  ds_read_b64_tr_b16 v[50:51], v8 offset:8704
  v_fma_f32 v66, v30, s41, v66
  v_max_f32 v67, s40, v67
  v_fma_f32 v68, v68, v18, s42
  s_waitcnt lgkmcnt(4)
  v_mfma_f32_32x32x16_bf16 v[80:95], v[56:59], v[152:155], v[80:95]
  ds_read_b64_tr_b16 v[52:53], v9 offset:8192
  ds_read_b64_tr_b16 v[54:55], v9 offset:8704
  v_exp_f32 v33, v33 clamp
  v_mul_f32 v34, v70, v17
  v_fma_f32 v67, v31, s41, v67
  s_waitcnt lgkmcnt(4)
  v_mfma_f32_32x32x16_bf16 v[80:95], v[60:63], v[156:159], v[80:95]
  ds_read_b64_tr_b16 v[56:57], v10 offset:8192
  ds_read_b64_tr_b16 v[58:59], v10 offset:8704
  v_max_f32 v68, s40, v68
  v_fma_f32 v69, v69, v18, s42
  v_exp_f32 v34, v34 clamp
  s_waitcnt vmcnt(15)
  s_barrier
  s_waitcnt lgkmcnt(4)
  v_mfma_f32_32x32x16_bf16 v[80:95], v[48:51], v[160:163], v[80:95]
  ds_read_b64_tr_b16 v[60:61], v11 offset:8192
  ds_read_b64_tr_b16 v[62:63], v11 offset:8704
  s_add_u32 m0, s35, 16384
  v_mul_f32 v35, v71, v17
  v_cvt_pk_bf16_f32 v37, v66, v67
  v_fma_f32 v68, v32, s41, v68
  buffer_load_dwordx4 v7, s[12:15], s31 offen lds
  v_mfma_f32_16x16x32_bf16 v[20:23], v[24:27], v[48:51], v[20:23]
  s_waitcnt lgkmcnt(4)
  v_mfma_f32_32x32x16_bf16 v[80:95], v[52:55], v[164:167], v[80:95]
  ds_read_b64_tr_b16 v[48:49], v8 offset:10240
  ds_read_b64_tr_b16 v[50:51], v8 offset:10752
  v_max_f32 v69, s40, v69
  v_fma_f32 v70, v70, v18, s42
  v_exp_f32 v35, v35 clamp
  s_waitcnt lgkmcnt(4)
  v_mfma_f32_32x32x16_bf16 v[80:95], v[56:59], v[168:171], v[80:95]
  ds_read_b64_tr_b16 v[52:53], v9 offset:10240
  ds_read_b64_tr_b16 v[54:55], v9 offset:10752
  v_mul_f32 v28, v72, v17
  buffer_store_dwordx2 v[36:37], v1, s[16:19], s43 offen offset:0 sc1
  v_fma_f32 v69, v33, s41, v69
  s_waitcnt lgkmcnt(4)
  v_mfma_f32_32x32x16_bf16 v[80:95], v[60:63], v[172:175], v[80:95]
  ds_read_b64_tr_b16 v[56:57], v10 offset:10240
  ds_read_b64_tr_b16 v[58:59], v10 offset:10752
  v_max_f32 v70, s40, v70
  v_fma_f32 v71, v71, v18, s42
  v_exp_f32 v28, v28 clamp
  s_waitcnt lgkmcnt(4)
  v_mfma_f32_32x32x16_bf16 v[80:95], v[48:51], v[176:179], v[80:95]
  ds_read_b64_tr_b16 v[60:61], v11 offset:10240
  ds_read_b64_tr_b16 v[62:63], v11 offset:10752
  v_mul_f32 v29, v73, v17
  v_cvt_pk_bf16_f32 v38, v68, v69
  v_fma_f32 v70, v34, s41, v70
  buffer_load_dwordx4 v6, s[12:15], s31 offen offset:1024 lds
  s_add_u32 s31, s31, 4293001344
  s_sub_u32 s35, s35, s34
  v_mfma_f32_16x16x32_bf16 v[20:23], v[24:27], v[48:51], v[20:23]
  s_waitcnt lgkmcnt(4)
  v_mfma_f32_32x32x16_bf16 v[80:95], v[52:55], v[180:183], v[80:95]
  ds_read_b64_tr_b16 v[48:49], v8 offset:12288
  ds_read_b64_tr_b16 v[50:51], v8 offset:12800
  v_max_f32 v71, s40, v71
  v_fma_f32 v72, v72, v18, s42
  v_exp_f32 v29, v29 clamp
  s_waitcnt lgkmcnt(4)
  v_mfma_f32_32x32x16_bf16 v[80:95], v[56:59], v[184:187], v[80:95]
  ds_read_b64_tr_b16 v[52:53], v9 offset:12288
  ds_read_b64_tr_b16 v[54:55], v9 offset:12800
  v_mul_f32 v30, v74, v17
  v_fma_f32 v71, v35, s41, v71
  v_max_f32 v72, s40, v72
  s_waitcnt lgkmcnt(4)
  v_mfma_f32_32x32x16_bf16 v[80:95], v[60:63], v[188:191], v[80:95]
  ds_read_b64_tr_b16 v[56:57], v10 offset:12288
  ds_read_b64_tr_b16 v[58:59], v10 offset:12800
  v_fma_f32 v73, v73, v18, s42
  v_exp_f32 v30, v30 clamp
  v_mul_f32 v31, v75, v17
  s_waitcnt vmcnt(15)
  s_barrier
  s_waitcnt lgkmcnt(4)
  v_mfma_f32_32x32x16_bf16 v[80:95], v[48:51], v[192:195], v[80:95]
  ds_read_b64_tr_b16 v[60:61], v11 offset:12288
  ds_read_b64_tr_b16 v[62:63], v11 offset:12800
  s_mov_b32 m0, s70
  v_lshlrev_b32 v12, 4, v0
  s_and_b32 s36, s66, 0xfffff000
  s_lshl_b32 s67, s28, 11
  s_add_u32 s36, s36, s67
  buffer_load_dwordx4 v12, s[16:19], s36 offen sc1 lds
  v_cvt_pk_bf16_f32 v39, v70, v71
  v_fma_f32 v72, v28, s41, v72
  v_max_f32 v73, s40, v73
  v_mfma_f32_16x16x32_bf16 v[20:23], v[24:27], v[48:51], v[20:23]
  s_waitcnt lgkmcnt(4)
  v_mfma_f32_32x32x16_bf16 v[80:95], v[52:55], v[196:199], v[80:95]
  ds_read_b64_tr_b16 v[48:49], v8 offset:14336
  ds_read_b64_tr_b16 v[50:51], v8 offset:14848
  v_fma_f32 v74, v74, v18, s42
  v_exp_f32 v31, v31 clamp
  v_mul_f32 v32, v76, v17
  s_waitcnt lgkmcnt(4)
  v_mfma_f32_32x32x16_bf16 v[80:95], v[56:59], v[200:203], v[80:95]
  ds_read_b64_tr_b16 v[52:53], v9 offset:14336
  ds_read_b64_tr_b16 v[54:55], v9 offset:14848
  buffer_store_dwordx2 v[38:39], v1, s[16:19], s43 offen offset:512 sc1
  v_fma_f32 v73, v29, s41, v73
  v_max_f32 v74, s40, v74
  s_waitcnt lgkmcnt(4)
  v_mfma_f32_32x32x16_bf16 v[80:95], v[60:63], v[204:207], v[80:95]
  ds_read_b64_tr_b16 v[56:57], v10 offset:14336
  ds_read_b64_tr_b16 v[58:59], v10 offset:14848
  v_fma_f32 v75, v75, v18, s42
  v_exp_f32 v32, v32 clamp
  v_mul_f32 v33, v77, v17
  s_waitcnt lgkmcnt(4)
  v_mfma_f32_32x32x16_bf16 v[80:95], v[48:51], v[208:211], v[80:95]
  ds_read_b64_tr_b16 v[60:61], v11 offset:14336
  ds_read_b64_tr_b16 v[62:63], v11 offset:14848
  buffer_load_dwordx4 v12, s[16:19], s36 offen offset:1024 sc1 lds
  v_cvt_pk_bf16_f32 v36, v72, v73
  v_fma_f32 v74, v30, s41, v74
  v_max_f32 v75, s40, v75
  v_mfma_f32_16x16x32_bf16 v[20:23], v[24:27], v[48:51], v[20:23]
  s_waitcnt lgkmcnt(4)
  v_mfma_f32_32x32x16_bf16 v[80:95], v[52:55], v[212:215], v[80:95]
  ds_read_b64_tr_b16 v[48:49], v8 offset:16384
  ds_read_b64_tr_b16 v[50:51], v8 offset:16896
  v_fma_f32 v76, v76, v18, s42
  v_exp_f32 v33, v33 clamp
  v_mul_f32 v34, v78, v17
  s_waitcnt lgkmcnt(4)
  v_mfma_f32_32x32x16_bf16 v[80:95], v[56:59], v[216:219], v[80:95]
  ds_read_b64_tr_b16 v[52:53], v9 offset:16384
  ds_read_b64_tr_b16 v[54:55], v9 offset:16896
  v_fma_f32 v75, v31, s41, v75
  v_max_f32 v76, s40, v76
  v_fma_f32 v77, v77, v18, s42
  s_waitcnt lgkmcnt(4)
  v_mfma_f32_32x32x16_bf16 v[80:95], v[60:63], v[220:223], v[80:95]
  ds_read_b64_tr_b16 v[56:57], v10 offset:16384
  ds_read_b64_tr_b16 v[58:59], v10 offset:16896
  v_exp_f32 v34, v34 clamp
  v_mul_f32 v35, v79, v17
  v_cvt_pk_bf16_f32 v37, v74, v75
  s_waitcnt vmcnt(15)
  s_barrier
  s_waitcnt lgkmcnt(4)
  v_mfma_f32_32x32x16_bf16 v[80:95], v[48:51], v[224:227], v[80:95]
  ds_read_b64_tr_b16 v[60:61], v11 offset:16384
  ds_read_b64_tr_b16 v[62:63], v11 offset:16896
  v_fma_f32 v76, v32, s41, v76
  v_max_f32 v77, s40, v77
  s_bfe_u32 s32, s2, 0x20001
  s_lshl_b32 s32, s32, 3
  s_lshr_b32 s33, s2, 5
  s_add_u32 s32, s32, s33
  v_mfma_f32_16x16x32_bf16 v[20:23], v[24:27], v[48:51], v[20:23]
  s_waitcnt lgkmcnt(4)
  v_mfma_f32_32x32x16_bf16 v[80:95], v[52:55], v[228:231], v[80:95]
  ds_read_b64_tr_b16 v[48:49], v8 offset:18432
  ds_read_b64_tr_b16 v[50:51], v8 offset:18944
  v_add_u32 v8, s34, v8
  v_fma_f32 v78, v78, v18, s42
  v_exp_f32 v35, v35 clamp
  s_lshl_b32 s32, s32, 3
  s_add_u32 s32, s32, s26
  s_lshl_b32 s32, s32, 15
  s_lshl_b32 s33, s26, 2
  s_waitcnt lgkmcnt(4)
  v_mfma_f32_32x32x16_bf16 v[80:95], v[56:59], v[232:235], v[80:95]
  ds_read_b64_tr_b16 v[52:53], v9 offset:18432
  ds_read_b64_tr_b16 v[54:55], v9 offset:18944
  v_add_u32 v9, s34, v9
  buffer_store_dwordx2 v[36:37], v1, s[16:19], s43 offen offset:1024 sc1
  v_fma_f32 v77, v33, s41, v77
  v_lshrrev_b32 v7, 4, v0
  v_add_u32 v7, s33, v7
  v_xor_b32 v7, v7, v0
  v_and_b32 v7, 7, v7
  s_waitcnt lgkmcnt(4)
  v_mfma_f32_32x32x16_bf16 v[80:95], v[60:63], v[236:239], v[80:95]
  ds_read_b64_tr_b16 v[56:57], v10 offset:18432
  ds_read_b64_tr_b16 v[58:59], v10 offset:18944
  v_add_u32 v10, s34, v10
  v_max_f32 v78, s40, v78
  v_fma_f32 v79, v79, v18, s42
  v_lshrrev_b32 v6, 3, v0
  v_lshlrev_b32 v6, 12, v6
  v_lshl_add_u32 v6, v7, 4, v6
  s_lshl_b32 s33, s26, 10
  s_waitcnt lgkmcnt(4)
  v_mfma_f32_32x32x16_bf16 v[80:95], v[48:51], v[240:243], v[80:95]
  ds_read_b64_tr_b16 v[60:61], v11 offset:18432
  ds_read_b64_tr_b16 v[62:63], v11 offset:18944
  v_add_u32 v11, s34, v11
  v_cvt_pk_bf16_f32 v38, v76, v77
  v_fma_f32 v78, v34, s41, v78
  v_mfma_f32_16x16x32_bf16 v[20:23], v[24:27], v[48:51], v[20:23]
  s_waitcnt lgkmcnt(4)
  v_mfma_f32_32x32x16_bf16 v[80:95], v[52:55], v[244:247], v[80:95]
  ds_read_b64_tr_b16 v[48:49], v8 offset:0
  ds_read_b64_tr_b16 v[50:51], v8 offset:512
  v_max_f32 v79, s40, v79
  v_fma_f32 v79, v35, s41, v79
  s_waitcnt lgkmcnt(4)
  v_mfma_f32_32x32x16_bf16 v[80:95], v[56:59], v[248:251], v[80:95]
  ds_write_b32 v2, v20
  v_add_u32 v2, 139264, v2
  ds_read_b64_tr_b16 v[52:53], v9 offset:0
  ds_read_b64_tr_b16 v[54:55], v9 offset:512
  v_cvt_pk_bf16_f32 v39, v78, v79
  buffer_store_dwordx2 v[38:39], v1, s[16:19], s43 offen offset:1536 sc1
  s_waitcnt lgkmcnt(5)
  v_mfma_f32_32x32x16_bf16 v[64:79], v[60:63], v[252:255], v[80:95]
  ds_read_b64_tr_b16 v[56:57], v10 offset:0
  ds_read_b64_tr_b16 v[58:59], v10 offset:512
  s_mov_b32 s43, s64
  s_mov_b32 s64, s3
  s_add_u32 s3, s3, 4096
  s_cmp_ge_u32 s71, 20
  s_mov_b32 s40, 0x358637bd
  s_cselect_b32 s40, 0xff800000, s40
  s_cselect_b32 s41, 0, 1.0
  s_cselect_b32 s42, 0, 0x358637bd
  s_add_u32 s71, s71, 1
  s_branch K1_bodyL
Lrare_2:
  v_add_f32 v28, v28, v30
  v_add_f32 v29, v29, v31
  v_mov_b32 v30, v28
  v_mov_b32 v31, v29
  s_nop 0
  v_permlane32_swap_b32 v28, v30
  v_permlane32_swap_b32 v29, v31
  v_add_f32 v28, v28, v30
  v_add_f32 v29, v29, v31
  v_mul_f32 v19, 0xbacccccd, v29
  v_mul_f32 v28, 0x3acccccd, v28
  v_fma_f32 v28, -v19, v19, v28
  v_max_f32 v28, 0, v28
  v_add_f32 v28, 0x3727c5ac, v28
  v_rsq_f32 v18, v28
  v_sqrt_f32 v14, v28
  v_mul_f32 v17, 0x3fb8aa3b, v18
  v_mul_f32 v16, 0xc0135761, v18
  v_mul_f32 v15, v18, v18
  v_mul_f32 v15, v15, v18
  v_mul_f32 v15, 0xbdd2d3e8, v15
  s_branch K1_tail
Lrare_4:
Lz0_85:
  s_cmp_eq_u32 s56, 16
  s_cbranch_scc1 Lz1_86
  buffer_load_dword v34, off, s[20:23], 0 sc1
  s_waitcnt vmcnt(0)
  v_readfirstlane_b32 s56, v34
  s_branch Lz0_85
Lz1_86:
  s_branch Lback_5
Lrare_6:
  v_and_b32 v128, 31, v0
  v_lshlrev_b32 v128, 3, v128
  v_lshrrev_b32 v129, 5, v0
  v_mul_u32_u24 v129, 1792, v129
  v_add_u32 v128, v128, v129
  s_and_b32 s36, s66, 0xfffff000
  buffer_load_dwordx2 v[96:97], v128, s[16:19], s36 offen offset:0 sc1
  buffer_load_dwordx2 v[98:99], v128, s[16:19], s36 offen offset:256 sc1
  buffer_load_dwordx2 v[100:101], v128, s[16:19], s36 offen offset:512 sc1
  buffer_load_dwordx2 v[102:103], v128, s[16:19], s36 offen offset:768 sc1
  buffer_load_dwordx2 v[104:105], v128, s[16:19], s36 offen offset:1024 sc1
  buffer_load_dwordx2 v[106:107], v128, s[16:19], s36 offen offset:1280 sc1
  buffer_load_dwordx2 v[108:109], v128, s[16:19], s36 offen offset:1536 sc1
  s_branch Lback_7
Lrare_9:
  s_waitcnt vmcnt(1)
Lpoll_87:
  v_and_b32 v120, v97, v99
  v_and_b32 v121, v101, v103
  v_and_b32 v122, v105, v107
  v_and_b32 v120, v120, v109
  v_and_b32 v121, v121, v122
  v_and_b32 v120, v120, v121
  v_cmp_gt_i32 vcc, 0, v120
  s_nop 0
  s_cmp_eq_u64 vcc, -1
  s_cbranch_scc1 Lok_88
  v_and_b32 v128, 31, v0
  v_lshlrev_b32 v128, 3, v128
  v_lshrrev_b32 v129, 5, v0
  v_mul_u32_u24 v129, 1792, v129
  v_add_u32 v128, v128, v129
  s_and_b32 s36, s66, 0xfffff000
  buffer_load_dwordx2 v[96:97], v128, s[16:19], s36 offen offset:0 sc1
  buffer_load_dwordx2 v[98:99], v128, s[16:19], s36 offen offset:256 sc1
  buffer_load_dwordx2 v[100:101], v128, s[16:19], s36 offen offset:512 sc1
  buffer_load_dwordx2 v[102:103], v128, s[16:19], s36 offen offset:768 sc1
  buffer_load_dwordx2 v[104:105], v128, s[16:19], s36 offen offset:1024 sc1
  buffer_load_dwordx2 v[106:107], v128, s[16:19], s36 offen offset:1280 sc1
  buffer_load_dwordx2 v[108:109], v128, s[16:19], s36 offen offset:1536 sc1
  s_waitcnt vmcnt(0)
  s_branch Lpoll_87
Lok_88:
  v_add_f32 v96, v96, v104
  v_add_f32 v97, v97, v105
  v_add_f32 v98, v98, v106
  v_add_f32 v99, v99, v107
  v_add_f32 v100, v100, v108
  v_add_f32 v101, v101, v109
  v_add_f32 v96, v96, v102
  v_add_f32 v97, v97, v103
  v_add_f32 v98, v98, v100
  v_add_f32 v99, v99, v101
  v_add_f32 v96, v96, v98
  v_add_f32 v97, v97, v99
  v_mov_b32 v98, v96
  v_mov_b32 v99, v97
  v_lshlrev_b32 v120, 16, v40
  v_and_b32 v121, 0xffff0000, v40
  v_permlane32_swap_b32 v96, v98
  v_permlane32_swap_b32 v97, v99
  v_add_f32 v96, v96, v98
  v_add_f32 v97, v97, v99
  v_mul_f32 v96, 0xba97b426, v96
  v_mul_f32 v97, 0xba97b426, v97
  v_fma_f32 v97, -v96, v96, v97
  v_max_f32 v97, 0, v97
  v_add_f32 v97, 0x3727c5ac, v97
  v_rsq_f32 v97, v97
  v_lshlrev_b32 v122, 16, v41
  v_and_b32 v123, 0xffff0000, v41
  v_add_f32 v120, v120, v96
  v_add_f32 v121, v121, v96
  v_lshlrev_b32 v124, 16, v42
  v_and_b32 v125, 0xffff0000, v42
  v_mul_f32 v120, v120, v97
  v_mul_f32 v121, v121, v97
  v_cvt_pk_bf16_f32 v112, v120, v121
  v_add_f32 v122, v122, v96
  v_add_f32 v123, v123, v96
  v_lshlrev_b32 v126, 16, v43
  v_and_b32 v127, 0xffff0000, v43
  v_mul_f32 v122, v122, v97
  v_mul_f32 v123, v123, v97
  v_cvt_pk_bf16_f32 v113, v122, v123
  v_add_f32 v124, v124, v96
  v_add_f32 v125, v125, v96
  v_lshlrev_b32 v120, 16, v44
  v_and_b32 v121, 0xffff0000, v44
  v_mul_f32 v124, v124, v97
  v_mul_f32 v125, v125, v97
  v_cvt_pk_bf16_f32 v114, v124, v125
  v_add_f32 v126, v126, v96
  v_add_f32 v127, v127, v96
  v_lshlrev_b32 v122, 16, v45
  v_and_b32 v123, 0xffff0000, v45
  v_mul_f32 v126, v126, v97
  v_mul_f32 v127, v127, v97
  v_cvt_pk_bf16_f32 v115, v126, v127
  v_add_f32 v120, v120, v96
  v_add_f32 v121, v121, v96
  v_lshlrev_b32 v124, 16, v46
  v_and_b32 v125, 0xffff0000, v46
  v_mul_f32 v120, v120, v97
  v_mul_f32 v121, v121, v97
  v_cvt_pk_bf16_f32 v116, v120, v121
  v_add_f32 v122, v122, v96
  v_add_f32 v123, v123, v96
  v_lshlrev_b32 v126, 16, v47
  v_and_b32 v127, 0xffff0000, v47
  v_mul_f32 v122, v122, v97
  v_mul_f32 v123, v123, v97
  v_cvt_pk_bf16_f32 v117, v122, v123
  v_add_f32 v124, v124, v96
  v_add_f32 v125, v125, v96
  v_mul_f32 v124, v124, v97
  v_mul_f32 v125, v125, v97
  v_cvt_pk_bf16_f32 v118, v124, v125
  v_add_f32 v126, v126, v96
  v_add_f32 v127, v127, v96
  v_mul_f32 v126, v126, v97
  v_mul_f32 v127, v127, v97
  v_cvt_pk_bf16_f32 v119, v126, v127
  buffer_store_dwordx4 v[112:115], v5, s[16:19], s69 offen sc1
  buffer_store_dwordx4 v[116:119], v4, s[16:19], s69 offen sc1
  s_branch Lback_10
Lrare_12:
  s_mov_b32 s20, s60
  s_and_b32 s21, s61, 0xffff
  s_mov_b32 s22, 0x100
  s_mov_b32 s23, 0x20000
Lz0_89:
  s_sleep 2
  buffer_load_dword v20, off, s[20:23], 0 sc1
  s_waitcnt vmcnt(0)
  v_readfirstlane_b32 s70, v20
  s_nop 0
  s_cmp_eq_u32 s70, 16
  s_cbranch_scc0 Lz0_89
  s_branch Lback_13
Lrare_15:
  s_waitcnt vmcnt(0)
  s_barrier
  s_cmp_lg_u32 s26, 0
  s_cbranch_scc1 K2_lw
  buffer_load_dword v20, v21, s[16:19], s39 offen sc1
  s_waitcnt vmcnt(0)
Lchk_90:
  v_cmp_eq_u32 s[46:47], 14, v20
  s_nop 0
  s_cmp_eq_u64 s[46:47], -1
  s_cbranch_scc1 Lok_91
  s_sleep 3
  v_cmp_eq_u32 s[46:47], 0, v20
  s_nop 0
  s_cmp_eq_u64 s[46:47], 0
  s_cbranch_scc1 Lsl_92
  s_sleep 24
Lsl_92:
  buffer_load_dword v20, v21, s[16:19], s39 offen sc1
  s_waitcnt vmcnt(0)
  s_branch Lchk_90
Lok_91:
K2_lw:
  s_barrier
  s_add_u32 m0, s67, 124928
  s_nop 0
  buffer_load_dwordx4 v10, s[16:19], s30 offen offset:0 sc1 lds
  buffer_load_dwordx4 v10, s[16:19], s30 offen offset:1024 sc1 lds
  buffer_load_dwordx4 v10, s[16:19], s30 offen offset:2048 sc1 lds
  s_cbranch_vccnz Lsk_93
  buffer_load_dwordx4 v10, s[16:19], s30 offen offset:3072 sc1 lds
Lsk_93:
  s_add_u32 s30, s30, 221184
  s_add_u32 m0, s67, 139264
  s_nop 0
  buffer_load_dwordx4 v10, s[16:19], s30 offen offset:0 sc1 lds
  buffer_load_dwordx4 v10, s[16:19], s30 offen offset:1024 sc1 lds
  buffer_load_dwordx4 v10, s[16:19], s30 offen offset:2048 sc1 lds
  s_cbranch_vccnz Lsk_94
  buffer_load_dwordx4 v10, s[16:19], s30 offen offset:3072 sc1 lds
Lsk_94:
  s_add_u32 s30, s30, 221184
  s_add_u32 m0, s67, 81920
  s_nop 0
  buffer_load_dwordx4 v10, s[16:19], s30 offen offset:0 sc1 lds
  buffer_load_dwordx4 v10, s[16:19], s30 offen offset:1024 sc1 lds
  buffer_load_dwordx4 v10, s[16:19], s30 offen offset:2048 sc1 lds
  s_cbranch_vccnz Lsk_95
  buffer_load_dwordx4 v10, s[16:19], s30 offen offset:3072 sc1 lds
Lsk_95:
  s_add_u32 s30, s30, 221184
  s_branch Lback_16
K1_side:
  s_waitcnt lgkmcnt(0)
  s_mov_b32 s16, s62
  s_and_b32 s17, s63, 0xffff
  s_mov_b32 s18, 0x1730000
  s_mov_b32 s19, 0x20000
  s_mov_b32 s20, s60
  s_and_b32 s21, s61, 0xffff
  s_mov_b32 s22, 0x100
  s_mov_b32 s23, 0x20000
  v_mov_b32 v8, 0
  v_mov_b32 v9, 0
  v_mov_b32 v10, 0
  v_mov_b32 v11, 0
  v_mov_b32 v12, 1
  v_lshlrev_b32 v6, 4, v0
  s_lshl_b32 s36, s24, 3
  s_add_u32 s36, s36, s26
  s_lshl_b32 s36, s36, 11
  s_add_u32 s36, s36, 0x16b0000
  buffer_store_dwordx4 v[8:11], v6, s[16:19], s36 offen sc1
  buffer_store_dwordx4 v[8:11], v6, s[16:19], s36 offen offset:1024 sc1
  s_mul_i32 s36, s24, 6
  s_add_u32 s36, s36, s26
  s_lshl_b32 s36, s36, 10
  s_add_u32 s36, s36, 0x1680000
  s_lshl_b32 s67, s24, 11
  s_add_u32 s67, s67, 0x16a0000
  s_and_b32 s68, s26, 1
  s_lshl_b32 s68, s68, 10
  s_add_u32 s68, s68, s67
  s_cmp_ge_u32 s26, 6
  s_cselect_b32 s36, s68, s36
  buffer_store_dwordx4 v[8:11], v6, s[16:19], s36 offen sc1
  s_waitcnt vmcnt(0)
  s_barrier
  s_cmp_lg_u32 s26, 6
  s_cbranch_scc1 K1_nofl2
  s_mov_b64 exec, 1
  buffer_atomic_add v12, off, s[20:23], 0 sc1
  s_mov_b64 exec, -1
K1_nofl2:
  s_barrier
  s_mov_b32 s20, s58
  s_and_b32 s21, s59, 0xffff
  s_mov_b32 s22, 0x800000
  s_mov_b32 s23, 0x20000
  s_lshl_b32 s36, s24, 3
  s_add_u32 s36, s36, s26
  s_lshl_b32 s36, s36, 16
  s_add_u32 s68, s36, 32768
  v_and_b32 v97, 7, v0
  v_lshlrev_b32 v97, 7, v97
  v_lshrrev_b32 v96, 3, v0
  v_lshl_add_u32 v97, v96, 12, v97
  buffer_load_dword v100, v97, s[20:23], s36 offen offset:2048
  buffer_load_dword v101, v97, s[20:23], s68 offen offset:2048
  buffer_load_dword v102, v97, s[20:23], s36 offen offset:3072
  buffer_load_dword v103, v97, s[20:23], s68 offen offset:3072
  s_add_u32 s71, s67, 1024
  s_mov_b32 s70, 0
  s_mov_b32 s69, 1
P2_late:
  s_mov_b32 s20, s58
  s_and_b32 s21, s59, 0xffff
  s_mov_b32 s22, 0x800000
  s_mov_b32 s23, 0x20000
  s_bfe_u32 s29, s2, 0x20001
  s_lshl_b32 s29, s29, 3
  s_lshr_b32 s36, s2, 5
  s_add_u32 s29, s29, s36
  s_lshl_b32 s29, s29, 1
  s_and_b32 s36, s2, 1
  s_add_u32 s29, s29, s36
  s_lshl_b32 s29, s29, 2
  s_bfe_u32 s36, s2, 0x20003
  s_add_u32 s29, s29, s36
  s_lshl_b32 s29, s29, 3
  s_add_u32 s29, s29, s26
  s_lshl_b32 s29, s29, 12
  v_min_u32 v99, 15, v0
  v_lshlrev_b32 v99, 7, v99
  buffer_load_dword v98, v99, s[20:23], s29 offen
  s_load_dwordx2 s[44:45], s[0:1], 16
  s_load_dwordx2 s[46:47], s[0:1], 56
  s_load_dwordx4 s[48:51], s[0:1], 40
  s_load_dwordx2 s[52:53], s[0:1], 80
  s_load_dwordx2 s[54:55], s[0:1], 0
  s_load_dwordx2 s[62:63], s[0:1], 64
  s_lshl_b32 s24, s24, 1
  s_and_b32 s36, s25, 1
  s_add_u32 s24, s24, s36
  s_waitcnt lgkmcnt(0)
  s_mov_b32 s8, s46
  s_and_b32 s9, s47, 0xffff
  s_mov_b32 s10, 0x10e000
  s_mov_b32 s11, 0x20000
  s_mov_b32 s67, -20
  s_cmp_lt_u32 s24, 20
  s_cselect_b32 s12, s44, s46
  s_cselect_b32 s13, s45, s47
  s_mov_b32 s14, 0x10e000
  s_cselect_b32 s14, 0xc8000, s14
  s_cselect_b32 s67, 0, s67
  s_and_b32 s13, s13, 0xffff
  s_mov_b32 s15, 0x20000
  s_mul_i32 s36, s26, 160
  v_add_u32 v120, 0, v0
  v_mul_u32_u24 v121, 205, v120
  v_lshrrev_b32 v121, 11, v121
  v_mul_u32_u24 v121, 1120, v121
  v_lshl_add_u32 v121, v120, 4, v121
  v_add_u32 v124, s36, v121
  v_add_u32 v120, 64, v0
  v_mul_u32_u24 v121, 205, v120
  v_lshrrev_b32 v121, 11, v121
  v_mul_u32_u24 v121, 1120, v121
  v_lshl_add_u32 v121, v120, 4, v121
  v_add_u32 v125, s36, v121
  v_add_u32 v120, 128, v0
  v_mul_u32_u24 v121, 205, v120
  v_lshrrev_b32 v121, 11, v121
  v_mul_u32_u24 v121, 1120, v121
  v_lshl_add_u32 v121, v120, 4, v121
  v_add_u32 v126, s36, v121
  v_add_u32 v120, 192, v0
  v_mul_u32_u24 v121, 205, v120
  v_lshrrev_b32 v121, 11, v121
  v_mul_u32_u24 v121, 1120, v121
  v_lshl_add_u32 v121, v120, 4, v121
  v_add_u32 v127, s36, v121
  v_add_u32 v120, 256, v0
  v_mul_u32_u24 v121, 205, v120
  v_lshrrev_b32 v121, 11, v121
  v_mul_u32_u24 v121, 1120, v121
  v_lshl_add_u32 v121, v120, 4, v121
  v_add_u32 v128, s36, v121
  s_add_u32 s67, s24, s67
  s_mul_i32 s31, s67, 40960
  s_add_u32 s67, s24, 12
  s_mul_i32 s30, s67, 40960
  buffer_load_dwordx4 v[132:135], v124, s[12:15], s31 offen
  buffer_load_dwordx4 v[136:139], v125, s[12:15], s31 offen
  buffer_load_dwordx4 v[140:143], v126, s[12:15], s31 offen
  buffer_load_dwordx4 v[144:147], v127, s[12:15], s31 offen
  buffer_load_dwordx4 v[148:151], v128, s[12:15], s31 offen
  buffer_load_dwordx4 v[152:155], v124, s[8:11], s30 offen
  buffer_load_dwordx4 v[156:159], v125, s[8:11], s30 offen
  buffer_load_dwordx4 v[160:163], v126, s[8:11], s30 offen
  buffer_load_dwordx4 v[164:167], v127, s[8:11], s30 offen
  buffer_load_dwordx4 v[168:171], v128, s[8:11], s30 offen
  v_lshlrev_b32 v122, 4, v0
  s_mul_i32 s36, s24, 40
  s_mul_i32 s67, s26, 5
  s_add_u32 s36, s36, s67
  s_lshl_b32 s36, s36, 10
  s_add_u32 s68, s36, 0x1480000
  s_waitcnt vmcnt(5)
  s_add_u32 s67, s68, 0
  buffer_store_dwordx4 v[132:135], v122, s[16:19], s67 offen sc1
  s_add_u32 s67, s68, 1024
  buffer_store_dwordx4 v[136:139], v122, s[16:19], s67 offen sc1
  s_add_u32 s67, s68, 2048
  buffer_store_dwordx4 v[140:143], v122, s[16:19], s67 offen sc1
  s_add_u32 s67, s68, 3072
  buffer_store_dwordx4 v[144:147], v122, s[16:19], s67 offen sc1
  s_add_u32 s67, s68, 4096
  buffer_store_dwordx4 v[148:151], v122, s[16:19], s67 offen sc1
  s_cmp_ge_u32 s24, 15
  s_cbranch_scc1 K1_rtd
  s_waitcnt vmcnt(5)
  s_add_u32 s67, s68, 1310720
  buffer_store_dwordx4 v[152:155], v122, s[16:19], s67 offen sc1
  s_add_u32 s67, s68, 1311744
  buffer_store_dwordx4 v[156:159], v122, s[16:19], s67 offen sc1
  s_add_u32 s67, s68, 1312768
  buffer_store_dwordx4 v[160:163], v122, s[16:19], s67 offen sc1
  s_add_u32 s67, s68, 1313792
  buffer_store_dwordx4 v[164:167], v122, s[16:19], s67 offen sc1
  s_add_u32 s67, s68, 1314816
  buffer_store_dwordx4 v[168:171], v122, s[16:19], s67 offen sc1
K1_rtd:
  s_waitcnt vmcnt(0)
  s_barrier
  s_mov_b32 s4, s58
  s_and_b32 s5, s59, 0xffff
  s_mov_b32 s6, 0x800000
  s_mov_b32 s7, 0x20000
  s_bfe_u32 s32, s2, 0x20001
  s_lshl_b32 s32, s32, 3
  s_lshr_b32 s33, s2, 5
  s_add_u32 s32, s32, s33
  s_lshl_b32 s32, s32, 3
  s_add_u32 s32, s32, s26
  s_lshl_b32 s32, s32, 15
  s_lshl_b32 s33, s26, 2
  v_lshrrev_b32 v7, 4, v0
  v_add_u32 v7, s33, v7
  v_xor_b32 v7, v7, v0
  v_and_b32 v7, 7, v7
  v_lshrrev_b32 v6, 3, v0
  v_lshlrev_b32 v6, 12, v6
  v_lshl_add_u32 v6, v7, 4, v6
  s_lshl_b32 s33, s26, 10
  s_add_u32 m0, s33, 0
  s_nop 0
  buffer_load_dwordx4 v6, s[4:7], s32 offen offset:0 lds
  s_add_u32 m0, s33, 8064
  s_nop 0
  buffer_load_dwordx4 v6, s[4:7], s32 offen offset:128 lds
  s_add_u32 m0, s33, 16128
  s_nop 0
  buffer_load_dwordx4 v6, s[4:7], s32 offen offset:256 lds
  s_add_u32 m0, s33, 24192
  s_nop 0
  buffer_load_dwordx4 v6, s[4:7], s32 offen offset:384 lds
  s_add_u32 m0, s33, 32256
  s_nop 0
  buffer_load_dwordx4 v6, s[4:7], s32 offen offset:512 lds
  s_add_u32 m0, s33, 40320
  s_nop 0
  buffer_load_dwordx4 v6, s[4:7], s32 offen offset:640 lds
  v_and_b32 v21, 15, v0
  v_lshlrev_b32 v21, 11, v21
  v_lshlrev_b32 v10, 4, v0
  s_bfe_u32 s24, s2, 0x20001
  s_lshl_b32 s24, s24, 3
  s_lshr_b32 s36, s2, 5
  s_add_u32 s24, s24, s36
  s_and_b32 s25, s2, 1
  s_lshl_b32 s25, s25, 2
  s_bfe_u32 s36, s2, 0x20003
  s_add_u32 s25, s25, s36
  s_and_b32 s27, s26, 1
  s_bfe_u32 s28, s26, 0x10001
  s_cmp_ge_u32 s26, 4
  s_cbranch_scc1 Learly_96
  s_cmp_lg_u32 s70, 16
  s_cbranch_scc1 Lrare_97
Lback_98:
  s_and_b32 s39, s2, 7
  s_lshl_b32 s39, s39, 7
  s_add_u32 s39, s39, 0x16a0000
  v_lshrrev_b32 v11, 3, v0
  s_lshl_b32 s37, s26, 4
  v_add_u32 v11, s37, v11
  v_lshlrev_b32 v11, 12, v11
  v_lshrrev_b32 v6, 4, v0
  v_and_b32 v7, 7, v0
  v_xor_b32 v6, v6, v7
  v_lshl_add_u32 v8, v6, 4, v11
  v_xor_b32 v6, 4, v6
  v_lshl_add_u32 v9, v6, 4, v11
  v_add_u32 v9, 31744, v9
  s_lshl_b32 s29, s24, 18
  s_lshl_b32 s35, s26, 11
  s_mov_b32 s4, s48
  s_and_b32 s5, s49, 0xffff
  s_mov_b32 s6, 0x800000
  s_mov_b32 s7, 0x20000
  s_add_u32 s29, s29, 768
  s_mul_i32 s67, s28, 7
  s_lshl_b32 s37, s27, 2
  s_add_u32 s67, s67, s37
  s_lshl_b32 s67, s67, 10
  s_mul_i32 s30, s28, 108
  s_add_u32 s30, s30, s37
  s_mul_i32 s37, s25, 7
  s_add_u32 s30, s30, s37
  s_lshl_b32 s30, s30, 10
  s_add_u32 s30, s30, 7919616
  s_mov_b32 s46, s27
  s_mov_b32 s47, 0
  s_mov_b64 vcc, s[46:47]
Learly_96:
  s_cmp_lg_u32 s26, 0
  s_cbranch_scc1 Lnp_99
  buffer_load_dword v20, v21, s[16:19], s39 offen sc1
Lnp_99:
  s_waitcnt vmcnt(0)
  s_branch P2_entry
Lrare_97:
  s_mov_b32 s20, s60
  s_and_b32 s21, s61, 0xffff
  s_mov_b32 s22, 0x100
  s_mov_b32 s23, 0x20000
Lz0_100:
  s_sleep 2
  buffer_load_dword v20, off, s[20:23], 0 sc1
  s_waitcnt vmcnt(0)
  v_readfirstlane_b32 s70, v20
  s_nop 0
  s_cmp_eq_u32 s70, 16
  s_cbranch_scc0 Lz0_100
  s_branch Lback_98
K1_end:
  s_endpgm
CODE_END:
.section .rodata,"a"
.p2align 6
.amdhsa_kernel k1_kernel
  .amdhsa_next_free_vgpr 256
  .amdhsa_next_free_sgpr 72
  .amdhsa_accum_offset 256
  .amdhsa_group_segment_fixed_size 0
  .amdhsa_kernarg_size 88
  .amdhsa_user_sgpr_count 2
  .amdhsa_user_sgpr_kernarg_segment_ptr 1
  .amdhsa_system_sgpr_workgroup_id_x 1
.end_amdhsa_kernel
```
